```python
import torch

def _softmax(x, axis=-1):
    return torch.softmax(x, dim=axis)
def _gelu(x):
    return torch.nn.functional.gelu(x, approximate="tanh")
def _silu(x):
    return torch.nn.functional.silu(x)
def _sigmoid(x):
    return torch.sigmoid(x)
def _layernorm(x, axis=-1, eps=1e-5):
    m = x.mean(dim=axis, keepdim=True)
    v = x.var(dim=axis, keepdim=True, unbiased=False)
    return (x - m) / torch.sqrt(v + eps)
def _scatter_add(tgt, idx, src, axis=0):
    return tgt.clone().index_add_(axis, idx, src)
def _segment_sum(src, seg, n):
    out = torch.zeros((n,) + src.shape[1:], dtype=src.dtype)
    return out.index_add_(0, seg, src)
def _pad(x, pw):
    flat = tuple(v for pair in reversed(pw) for v in pair)
    return torch.nn.functional.pad(x, flat)

kernel_name = 'concat_heads__grouped_kv_mqa__spectral_fnet__prompt'

def setup_inputs():

    _w = (lambda a: (lambda t: t.to(torch.bfloat16) if t.is_floating_point() else t)(torch.as_tensor(a)))
    def _A_setup():
        B, S, D, H = 1, 2048, 448, 16
        Dh = D // H
        return {
            "x": _w((lambda *s: torch.randn(*s, dtype=torch.bfloat16) * 0.05)(B, S, D)),
            "wq": _w((lambda *s: torch.randn(*s, dtype=torch.bfloat16) * 3.2)(D, H * Dh)),
            "wk": _w((lambda *s: torch.randn(*s, dtype=torch.bfloat16) * 3.2)(D, Dh)),
            "wv": _w((lambda *s: torch.randn(*s, dtype=torch.bfloat16) * 0.4)(D, Dh)),
            "wo": _w((lambda *s: torch.randn(*s, dtype=torch.bfloat16) * 0.4)(H * Dh, D)),
        }
    _A_in = _A_setup()

    def _B_setup():
        B, S, D = 1, 2048, 448
        ns = torch.arange(S)[:, None] * torch.arange(S)[None, :]
        nd = torch.arange(D)[:, None] * torch.arange(D)[None, :]
        Ws_re = torch.cos(-2.0 * torch.pi * ns / S).to(float)
        Ws_im = torch.sin(-2.0 * torch.pi * ns / S).to(float)
        Wd_re = torch.cos(-2.0 * torch.pi * nd / D).to(float)
        Wd_im = torch.sin(-2.0 * torch.pi * nd / D).to(float)
        return {
            "x": _w((lambda *s: torch.randn(*s, dtype=torch.bfloat16) * 0.05)(B, S, D)),
            "dft_seq_re": _w(Ws_re),
            "dft_seq_im": _w(Ws_im),
            "dft_hid_re": _w(Wd_re),
            "dft_hid_im": _w(Wd_im),
        }
    _B_in = _B_setup()

    return {
        "A_x": _A_in["x"],
        "A_wq": _A_in["wq"],
        "A_wk": _A_in["wk"],
        "A_wv": _A_in["wv"],
        "A_wo": _A_in["wo"],
        "B_x": _B_in["x"],
        "B_dft_seq_re": _B_in["dft_seq_re"],
        "B_dft_seq_im": _B_in["dft_seq_im"],
        "B_dft_hid_re": _B_in["dft_hid_re"],
        "B_dft_hid_im": _B_in["dft_hid_im"],
    }

def reference(A_x, A_wq, A_wk, A_wv, A_wo, B_x, B_dft_seq_re, B_dft_seq_im, B_dft_hid_re, B_dft_hid_im):
    def _A_ref(x, wq, wk, wv, wo):
        B, S, D = x.shape
        H = 16
        Dh = D // H
        q = (lambda x, *d: x.permute(*d))((x @ wq).reshape(B, S, H, Dh), 0, 2, 1, 3)
        k = x @ wk
        v = x @ wv
        scores = torch.einsum("bhqd,bkd->bhqk", q, k) * (Dh ** -0.5)
        p = _softmax(scores, axis=-1)
        o = torch.einsum("bhqk,bkd->bhqd", p, v)
        return (lambda x, *d: x.permute(*d))(o, 0, 2, 1, 3).reshape(B, S, H * Dh) @ wo

    def _B_ref(x, dft_seq_re, dft_seq_im, dft_hid_re, dft_hid_im):
        a = torch.einsum("bsd,ed->bse", x, dft_hid_re)
        b = torch.einsum("bsd,ed->bse", x, dft_hid_im)
        y = torch.einsum("ts,bse->bte", dft_seq_re, a) - torch.einsum("ts,bse->bte", dft_seq_im, b)
        return y

    a = _A_ref(A_x, A_wq, A_wk, A_wv, A_wo)
    b = _B_ref(B_x, B_dft_seq_re, B_dft_seq_im, B_dft_hid_re, B_dft_hid_im)
    return torch.concatenate([a, b], axis=-1)
```

```asm
; @launch grid=(256,1,1) block=(256,1,1) lds=163840
.amdgcn_target "amdgcn-amd-amdhsa--gfx950"
.text
.globl concat_heads__grouped_kv_mqa__spectral_fnet__prompt_kernel
.p2align 8
.type concat_heads__grouped_kv_mqa__spectral_fnet__prompt_kernel,@function
concat_heads__grouped_kv_mqa__spectral_fnet__prompt_kernel:
  s_load_dwordx16 s[4:19], s[0:1], 0
  s_load_dwordx4 s[24:27], s[0:1], 80
  s_load_dwordx2 s[28:29], s[0:1], 96
  s_cmp_ge_u32 s2, 256
  s_cbranch_scc1 k_exit
  s_getpc_b64 s[36:37]
k_pc:
  s_and_b32 s39, s2, 0xf8
  v_lshrrev_b32 v2, 5, v0
  v_add_lshl_u32 v2, v2, s39, 7
  v_min_u32 v2, k_last-k_pc, v2
  v_mov_b32 v3, s37
  v_add_co_u32 v2, vcc, s36, v2
  s_nop 1
  v_addc_co_u32 v3, vcc, 0, v3, vcc
  global_load_dword v55, v[2:3], off
  v_lshrrev_b32 v1, 6, v0
  v_and_b32 v0, 63, v0
  v_readfirstlane_b32 s3, v1
  s_and_b32 s30, s2, 7
  s_lshr_b32 s39, s2, 6
  s_lshl2_add_u32 s30, s30, s39
  s_bfe_u32 s31, s2, 0x30003
  s_mul_i32 s39, s39, 2
  s_add_u32 s32, s31, s39
  s_sub_u32 s39, s32, 7
  s_cselect_b32 s32, s32, s39
  v_lshrrev_b32 v5, 4, v0
  v_and_b32 v6, 7, v0
  v_lshrrev_b32 v4, 3, v0
  v_xor_b32 v7, v6, v5
  v_lshlrev_b32 v7, 4, v7
  s_mov_b32 s74, 896
  v_mad_u32_u24 v8, v4, s74, v7
  v_xor_b32 v9, 64, v8
  v_add_u32 v9, 6144, v9
  s_lshl_b32 s64, s3, 11
  s_lshl2_add_u32 s65, s30, s3
  s_mul_i32 s65, s65, 14336
  s_mov_b32 s42, 1835008
  s_mov_b32 s43, 0x20000
  s_lshl2_add_u32 s73, s2, s3
  v_lshlrev_b32 v1, 4, v0
  v_and_b32 v2, 1, v5
  v_lshlrev_b32 v2, 2, v2
  v_xor_b32 v2, v2, v6
  v_lshlrev_b32 v2, 4, v2
  v_mad_u32_u24 v10, v4, s74, v2
  v_add_u32 v11, 7168, v10
  s_mul_i32 s69, s3, 896
  s_lshl_b32 s70, s31, 7
  s_lshl4_add_u32 s66, s69, s70
  s_mov_b32 s62, 401408
  s_cmp_eq_u32 s31, 7
  s_cselect_b64 vcc, -1, 0
  s_cselect_b32 s66, s69, s66
  s_cselect_b32 s69, s69, s64
  s_cselect_b32 s46, 25088, s62
  s_mov_b32 s50, s46
  v_cndmask_b32 v10, v10, v1, vcc
  v_cndmask_b32 v11, v11, v1, vcc
  s_mov_b32 s47, 0x20000
  s_mov_b32 s51, 0x20000
  s_lshr_b32 s71, s3, 1
  s_and_b32 s72, s3, 1
  s_waitcnt lgkmcnt(0)
  s_mov_b64 s[40:41], s[4:5]
  s_cmp_eq_u32 s73, 3
  s_cbranch_scc1 k_lead
k_nolead:
  s_add_u32 m0, s64, 0
  s_lshl_b32 s39, s32, 7
  s_add_u32 s39, s39, s65
  buffer_load_dwordx4 v8, s[40:43], s39 offen lds
  s_mov_b64 s[56:57], s[14:15]
  s_add_u32 s14, s69, 8192
  s_cmp_eq_u32 s31, 7
  s_cselect_b64 s[44:45], s[8:9], s[6:7]
  s_cselect_b64 s[48:49], s[10:11], s[6:7]
  s_mov_b32 s20, 57344
  s_cselect_b32 s20, 3584, s20
  s_movk_i32 s15, 1024
  s_cselect_b32 s15, 4096, s15
  buffer_load_dwordx4 v9, s[40:43], s39 offen offset:1024 lds
  s_add_u32 s15, s15, s14
  s_add_u32 m0, s14, 0
  s_mul_i32 s39, s32, s20
  s_add_u32 s39, s39, s66
  buffer_load_dwordx4 v10, s[44:47], s39 offen lds
  s_add_u32 s33, s32, 1
  s_cmp_eq_u32 s33, 7
  s_cselect_b32 s33, 0, s33
  s_add_u32 m0, s15, 0
  s_nop 0
  buffer_load_dwordx4 v11, s[48:51], s39 offen lds
  s_add_u32 s34, s33, 1
  s_cmp_eq_u32 s34, 7
  s_cselect_b32 s34, 0, s34
  s_add_u32 s35, s34, 1
  s_cmp_eq_u32 s35, 7
  s_cselect_b32 s35, 0, s35
  s_add_u32 s36, s35, 1
  s_cmp_eq_u32 s36, 7
  s_cselect_b32 s36, 0, s36
  s_add_u32 m0, s14, 16384
  s_mul_i32 s39, s33, s20
  s_add_u32 s39, s39, s66
  buffer_load_dwordx4 v10, s[44:47], s39 offen lds
  s_add_u32 s37, s36, 1
  s_cmp_eq_u32 s37, 7
  s_cselect_b32 s37, 0, s37
  s_add_u32 s38, s37, 1
  s_cmp_eq_u32 s38, 7
  s_cselect_b32 s38, 0, s38
  s_mov_b64 s[52:53], s[28:29]
  s_mov_b32 s54, 5287936
  s_add_u32 m0, s15, 16384
  s_nop 0
  buffer_load_dwordx4 v11, s[48:51], s39 offen lds
  s_mov_b32 s55, 0x20000
  s_mov_b32 s74, 57344
  v_mad_u32_u24 v12, v4, s74, v7
  v_xor_b32 v13, 64, v12
  v_add_u32 v13, 457728, v13
  s_and_b32 s67, s30, 15
  s_lshl1_add_u32 s67, s67, s71
  s_lshr_b32 s74, s30, 4
  s_add_u32 m0, s64, 16384
  s_lshl_b32 s39, s33, 7
  s_add_u32 s39, s39, s65
  buffer_load_dwordx4 v8, s[40:43], s39 offen lds
  s_lshl1_add_u32 s67, s67, s74
  s_lshl_b32 s74, s72, 10
  s_add_u32 s67, s67, s74
  s_mul_i32 s67, s67, 896
  s_mov_b32 s58, 1835008
  s_mov_b32 s59, 0x20000
  v_and_b32 v2, 31, v0
  v_lshrrev_b32 v3, 5, v0
  buffer_load_dwordx4 v9, s[40:43], s39 offen offset:1024 lds
  v_bfe_u32 v16, v0, 1, 3
  v_xor_b32 v16, v16, v3
  v_lshlrev_b32 v16, 4, v16
  v_lshl_add_u32 v16, v2, 7, v16
  s_lshl_b32 s74, s71, 12
  v_add_u32 v16, s74, v16
  v_xor_b32 v17, 32, v16
  v_xor_b32 v18, 64, v16
  s_add_u32 m0, s64, 32768
  s_lshl_b32 s39, s34, 7
  s_add_u32 s39, s39, s65
  buffer_load_dwordx4 v8, s[40:43], s39 offen lds
  v_xor_b32 v19, 96, v16
  v_add_u32 v20, 0x10000, v16
  v_add_u32 v21, 0x10000, v17
  v_add_u32 v22, 0x10000, v18
  v_add_u32 v23, 0x10000, v19
  s_cmp_eq_u32 s31, 7
  s_cselect_b32 s74, 56, 128
  s_cselect_b32 s75, 0, 64
  buffer_load_dwordx4 v9, s[40:43], s39 offen offset:1024 lds
  v_bfe_u32 v24, v0, 2, 2
  v_lshl_add_u32 v24, v3, 3, v24
  v_mul_u32_u24 v24, s74, v24
  v_and_b32 v2, 3, v0
  v_lshl_add_u32 v24, v2, 3, v24
  v_and_b32 v2, 1, v5
  v_lshl_add_u32 v24, v2, 5, v24
  v_and_b32 v2, 1, v4
  v_lshlrev_b32 v37, 10, v2
  v_xor_b32 v2, s72, v2
  v_mad_u32_u24 v24, v2, s75, v24
  v_add_u32 v25, 0x10000, v24
  s_lshl_b32 s74, s3, 8
  v_mov_b32 v35, s74
  v_and_b32 v34, 3, v4
  v_mul_u32_u24 v34, 7168, v34
  v_lshl_add_u32 v34, v3, 7, v34
  v_lshl_add_u32 v34, v6, 4, v34
  v_lshl_add_u32 v37, v5, 16, v37
  v_lshl_add_u32 v37, v6, 4, v37
  v_and_b32 v2, 15, v0
  v_bfe_u32 v7, v0, 1, 3
  v_xor_b32 v7, v7, v5
  v_lshlrev_b32 v7, 4, v7
  v_lshl_add_u32 v7, v2, 7, v7
  s_lshl_b32 s74, s72, 12
  v_add_u32 v26, s74, v7
  v_add_u32 v38, s64, v1
  v_xor_b32 v27, 64, v26
  v_add_u32 v28, 114688, v26
  v_add_u32 v29, 114688, v27
  v_lshlrev_b32 v36, 10, v5
  v_lshl_add_u32 v36, v2, 3, v36
  s_lshl_b32 s74, s71, 7
  s_lshl2_add_u32 s74, s72, s74
  v_add_u32 v36, s74, v36
  s_mov_b32 s16, s26
  s_mov_b32 s17, s27
  s_mov_b32 s18, 256
  s_mov_b32 s19, 0x20000
  v_mov_b32 v255, 1
  s_lshl_b32 s4, s31, 5
  s_add_u32 s4, s4, s71
  v_and_b32 v88, 15, v0
  v_lshl_add_u32 v88, v88, 1, s4
  s_lshl_b32 s4, s32, 3
  v_lshrrev_b32 v89, 4, v0
  v_add_u32 v89, s4, v89
  v_mul_u32_u24 v89, v88, v89
  v_mul_u32_u24 v90, 1171, v89
  v_lshrrev_b32 v90, 16, v90
  v_mul_u32_u24 v90, 56, v90
  v_sub_u32 v89, v90, v89
  v_cvt_f32_i32 v89, v89
  v_cvt_f32_u32 v88, v88
  v_mul_f32 v64, 1016219941, v89
  v_mul_f32 v89, 3138537765, v88
  v_mul_f32 v88, 3180480805, v88
  v_add_f32 v65, v64, v89
  v_add_f32 v66, v65, v89
  v_add_f32 v67, v66, v89
  v_add_f32 v68, v67, v89
  v_add_f32 v69, v68, v89
  v_add_f32 v70, v69, v89
  v_add_f32 v71, v70, v89
  v_add_f32 v80, v64, v88
  v_add_f32 v81, v65, v88
  v_add_f32 v82, v66, v88
  v_add_f32 v83, v67, v88
  v_add_f32 v84, v68, v88
  v_add_f32 v85, v69, v88
  v_add_f32 v86, v70, v88
  v_add_f32 v87, v71, v88
  v_cos_f32 v88, v88
  v_cos_f32 v56, v64
  v_sin_f32 v64, v64
  v_cos_f32 v57, v65
  v_sin_f32 v65, v65
  v_cos_f32 v58, v66
  v_sin_f32 v66, v66
  v_cos_f32 v59, v67
  v_sin_f32 v67, v67
  v_cos_f32 v60, v68
  v_sin_f32 v68, v68
  v_cos_f32 v61, v69
  v_sin_f32 v69, v69
  v_cos_f32 v62, v70
  v_sin_f32 v70, v70
  v_cos_f32 v63, v71
  v_sin_f32 v71, v71
  v_add_f32 v88, v88, v88
  v_cvt_pk_bf16_f32 v120, v56, v57
  v_cvt_pk_bf16_f32 v121, v58, v59
  v_cvt_pk_bf16_f32 v122, v60, v61
  v_cvt_pk_bf16_f32 v123, v62, v63
  v_cvt_pk_bf16_f32 v124, v64, v65
  v_cvt_pk_bf16_f32 v125, v66, v67
  v_cvt_pk_bf16_f32 v126, v68, v69
  v_cvt_pk_bf16_f32 v127, v70, v71
  v_cos_f32 v72, v80
  v_sin_f32 v80, v80
  v_cos_f32 v73, v81
  v_sin_f32 v81, v81
  v_cos_f32 v74, v82
  v_sin_f32 v82, v82
  v_cos_f32 v75, v83
  v_sin_f32 v83, v83
  v_cos_f32 v76, v84
  v_sin_f32 v84, v84
  v_cos_f32 v77, v85
  v_sin_f32 v85, v85
  v_cos_f32 v78, v86
  s_cmp_lg_u32 s73, 3
  s_cbranch_scc1 k_nolead2
  v_mov_b32 v48, 0
  s_mov_b64 exec, 1
  s_waitcnt vmcnt(10)
  buffer_store_dword v255, v48, s[16:19], 0 offen sc1
  s_mov_b64 exec, -1
k_nolead2:
  v_sin_f32 v86, v86
  v_cos_f32 v79, v87
  v_sin_f32 v87, v87
  v_cvt_pk_bf16_f32 v128, v72, v73
  v_cvt_pk_bf16_f32 v129, v74, v75
  v_cvt_pk_bf16_f32 v130, v76, v77
  v_cvt_pk_bf16_f32 v131, v78, v79
  v_cvt_pk_bf16_f32 v132, v80, v81
  v_cvt_pk_bf16_f32 v133, v82, v83
  v_cvt_pk_bf16_f32 v134, v84, v85
  v_cvt_pk_bf16_f32 v135, v86, v87
  v_pk_fma_f32 v[56:57], v[72:73], v[88:89], v[56:57] op_sel_hi:[1,0,1] neg_lo:[0,0,1] neg_hi:[0,0,1]
  v_pk_fma_f32 v[58:59], v[74:75], v[88:89], v[58:59] op_sel_hi:[1,0,1] neg_lo:[0,0,1] neg_hi:[0,0,1]
  v_pk_fma_f32 v[60:61], v[76:77], v[88:89], v[60:61] op_sel_hi:[1,0,1] neg_lo:[0,0,1] neg_hi:[0,0,1]
  v_pk_fma_f32 v[62:63], v[78:79], v[88:89], v[62:63] op_sel_hi:[1,0,1] neg_lo:[0,0,1] neg_hi:[0,0,1]
  v_pk_fma_f32 v[64:65], v[80:81], v[88:89], v[64:65] op_sel_hi:[1,0,1] neg_lo:[0,0,1] neg_hi:[0,0,1]
  v_pk_fma_f32 v[66:67], v[82:83], v[88:89], v[66:67] op_sel_hi:[1,0,1] neg_lo:[0,0,1] neg_hi:[0,0,1]
  v_pk_fma_f32 v[68:69], v[84:85], v[88:89], v[68:69] op_sel_hi:[1,0,1] neg_lo:[0,0,1] neg_hi:[0,0,1]
  v_pk_fma_f32 v[70:71], v[86:87], v[88:89], v[70:71] op_sel_hi:[1,0,1] neg_lo:[0,0,1] neg_hi:[0,0,1]
  v_cvt_pk_bf16_f32 v136, v56, v57
  v_cvt_pk_bf16_f32 v137, v58, v59
  v_cvt_pk_bf16_f32 v138, v60, v61
  v_cvt_pk_bf16_f32 v139, v62, v63
  v_cvt_pk_bf16_f32 v140, v64, v65
  v_cvt_pk_bf16_f32 v141, v66, v67
  v_cvt_pk_bf16_f32 v142, v68, v69
  v_cvt_pk_bf16_f32 v143, v70, v71
  v_pk_fma_f32 v[72:73], v[56:57], v[88:89], v[72:73] op_sel_hi:[1,0,1] neg_lo:[0,0,1] neg_hi:[0,0,1]
  v_pk_fma_f32 v[74:75], v[58:59], v[88:89], v[74:75] op_sel_hi:[1,0,1] neg_lo:[0,0,1] neg_hi:[0,0,1]
  v_pk_fma_f32 v[76:77], v[60:61], v[88:89], v[76:77] op_sel_hi:[1,0,1] neg_lo:[0,0,1] neg_hi:[0,0,1]
  v_pk_fma_f32 v[78:79], v[62:63], v[88:89], v[78:79] op_sel_hi:[1,0,1] neg_lo:[0,0,1] neg_hi:[0,0,1]
  v_pk_fma_f32 v[80:81], v[64:65], v[88:89], v[80:81] op_sel_hi:[1,0,1] neg_lo:[0,0,1] neg_hi:[0,0,1]
  v_pk_fma_f32 v[82:83], v[66:67], v[88:89], v[82:83] op_sel_hi:[1,0,1] neg_lo:[0,0,1] neg_hi:[0,0,1]
  v_pk_fma_f32 v[84:85], v[68:69], v[88:89], v[84:85] op_sel_hi:[1,0,1] neg_lo:[0,0,1] neg_hi:[0,0,1]
  v_pk_fma_f32 v[86:87], v[70:71], v[88:89], v[86:87] op_sel_hi:[1,0,1] neg_lo:[0,0,1] neg_hi:[0,0,1]
  v_cvt_pk_bf16_f32 v144, v72, v73
  v_cvt_pk_bf16_f32 v145, v74, v75
  v_cvt_pk_bf16_f32 v146, v76, v77
  v_cvt_pk_bf16_f32 v147, v78, v79
  v_cvt_pk_bf16_f32 v148, v80, v81
  v_cvt_pk_bf16_f32 v149, v82, v83
  v_cvt_pk_bf16_f32 v150, v84, v85
  v_cvt_pk_bf16_f32 v151, v86, v87
  v_pk_fma_f32 v[56:57], v[72:73], v[88:89], v[56:57] op_sel_hi:[1,0,1] neg_lo:[0,0,1] neg_hi:[0,0,1]
  v_pk_fma_f32 v[58:59], v[74:75], v[88:89], v[58:59] op_sel_hi:[1,0,1] neg_lo:[0,0,1] neg_hi:[0,0,1]
  v_pk_fma_f32 v[60:61], v[76:77], v[88:89], v[60:61] op_sel_hi:[1,0,1] neg_lo:[0,0,1] neg_hi:[0,0,1]
  v_pk_fma_f32 v[62:63], v[78:79], v[88:89], v[62:63] op_sel_hi:[1,0,1] neg_lo:[0,0,1] neg_hi:[0,0,1]
  v_pk_fma_f32 v[64:65], v[80:81], v[88:89], v[64:65] op_sel_hi:[1,0,1] neg_lo:[0,0,1] neg_hi:[0,0,1]
  v_pk_fma_f32 v[66:67], v[82:83], v[88:89], v[66:67] op_sel_hi:[1,0,1] neg_lo:[0,0,1] neg_hi:[0,0,1]
  v_pk_fma_f32 v[68:69], v[84:85], v[88:89], v[68:69] op_sel_hi:[1,0,1] neg_lo:[0,0,1] neg_hi:[0,0,1]
  v_pk_fma_f32 v[70:71], v[86:87], v[88:89], v[70:71] op_sel_hi:[1,0,1] neg_lo:[0,0,1] neg_hi:[0,0,1]
  v_cvt_pk_bf16_f32 v152, v56, v57
  v_cvt_pk_bf16_f32 v153, v58, v59
  v_cvt_pk_bf16_f32 v154, v60, v61
  v_cvt_pk_bf16_f32 v155, v62, v63
  v_cvt_pk_bf16_f32 v156, v64, v65
  v_cvt_pk_bf16_f32 v157, v66, v67
  v_cvt_pk_bf16_f32 v158, v68, v69
  v_cvt_pk_bf16_f32 v159, v70, v71
  v_pk_fma_f32 v[72:73], v[56:57], v[88:89], v[72:73] op_sel_hi:[1,0,1] neg_lo:[0,0,1] neg_hi:[0,0,1]
  v_pk_fma_f32 v[74:75], v[58:59], v[88:89], v[74:75] op_sel_hi:[1,0,1] neg_lo:[0,0,1] neg_hi:[0,0,1]
  v_pk_fma_f32 v[76:77], v[60:61], v[88:89], v[76:77] op_sel_hi:[1,0,1] neg_lo:[0,0,1] neg_hi:[0,0,1]
  v_pk_fma_f32 v[78:79], v[62:63], v[88:89], v[78:79] op_sel_hi:[1,0,1] neg_lo:[0,0,1] neg_hi:[0,0,1]
  v_pk_fma_f32 v[80:81], v[64:65], v[88:89], v[80:81] op_sel_hi:[1,0,1] neg_lo:[0,0,1] neg_hi:[0,0,1]
  v_pk_fma_f32 v[82:83], v[66:67], v[88:89], v[82:83] op_sel_hi:[1,0,1] neg_lo:[0,0,1] neg_hi:[0,0,1]
  v_pk_fma_f32 v[84:85], v[68:69], v[88:89], v[84:85] op_sel_hi:[1,0,1] neg_lo:[0,0,1] neg_hi:[0,0,1]
  v_pk_fma_f32 v[86:87], v[70:71], v[88:89], v[86:87] op_sel_hi:[1,0,1] neg_lo:[0,0,1] neg_hi:[0,0,1]
  v_cvt_pk_bf16_f32 v160, v72, v73
  v_cvt_pk_bf16_f32 v161, v74, v75
  v_cvt_pk_bf16_f32 v162, v76, v77
  v_cvt_pk_bf16_f32 v163, v78, v79
  v_cvt_pk_bf16_f32 v164, v80, v81
  v_cvt_pk_bf16_f32 v165, v82, v83
  v_cvt_pk_bf16_f32 v166, v84, v85
  v_cvt_pk_bf16_f32 v167, v86, v87
  v_pk_fma_f32 v[56:57], v[72:73], v[88:89], v[56:57] op_sel_hi:[1,0,1] neg_lo:[0,0,1] neg_hi:[0,0,1]
  v_pk_fma_f32 v[58:59], v[74:75], v[88:89], v[58:59] op_sel_hi:[1,0,1] neg_lo:[0,0,1] neg_hi:[0,0,1]
  v_pk_fma_f32 v[60:61], v[76:77], v[88:89], v[60:61] op_sel_hi:[1,0,1] neg_lo:[0,0,1] neg_hi:[0,0,1]
  v_pk_fma_f32 v[62:63], v[78:79], v[88:89], v[62:63] op_sel_hi:[1,0,1] neg_lo:[0,0,1] neg_hi:[0,0,1]
  v_pk_fma_f32 v[64:65], v[80:81], v[88:89], v[64:65] op_sel_hi:[1,0,1] neg_lo:[0,0,1] neg_hi:[0,0,1]
  v_pk_fma_f32 v[66:67], v[82:83], v[88:89], v[66:67] op_sel_hi:[1,0,1] neg_lo:[0,0,1] neg_hi:[0,0,1]
  v_pk_fma_f32 v[68:69], v[84:85], v[88:89], v[68:69] op_sel_hi:[1,0,1] neg_lo:[0,0,1] neg_hi:[0,0,1]
  v_pk_fma_f32 v[70:71], v[86:87], v[88:89], v[70:71] op_sel_hi:[1,0,1] neg_lo:[0,0,1] neg_hi:[0,0,1]
  v_cvt_pk_bf16_f32 v168, v56, v57
  v_cvt_pk_bf16_f32 v169, v58, v59
  v_cvt_pk_bf16_f32 v170, v60, v61
  v_cvt_pk_bf16_f32 v171, v62, v63
  v_cvt_pk_bf16_f32 v172, v64, v65
  v_cvt_pk_bf16_f32 v173, v66, v67
  v_cvt_pk_bf16_f32 v174, v68, v69
  v_cvt_pk_bf16_f32 v175, v70, v71
  v_lshlrev_b32 v254, 24, v0
  v_and_b32 v4, 15, v0
  v_min_u32 v3, 6, v4
  s_lshl_b32 s4, s30, 10
  v_lshl_add_u32 v3, v3, 7, s4
  v_min_u32 v251, 13, v4
  s_lshl_b32 s4, s3, 11
  s_add_u32 s5, s4, 32768
  v_cmp_lt_u32 vcc, 15, v0
  v_lshl_add_u32 v251, v251, 7, s5
  v_and_b32 v4, 7, v0
  v_cmp_lt_u32 vcc, 31, v0
  s_lshl2_add_u32 s4, s4, 896
  v_lshl_add_u32 v4, v4, 10, s4
  s_nop 0
  v_cndmask_b32 v3, v3, v4, vcc
  s_and_b32 s8, s2, 7
  s_lshl1_add_u32 s8, s8, s71
  s_min_u32 s8, s8, 13
  s_lshr_b32 s9, s2, 3
  s_lshl_b32 s4, s72, 9
  s_add_u32 s9, s9, s4
  s_sub_u32 s4, 13, s8
  s_cmp_ge_u32 s8, 7
  s_cselect_b64 vcc, -1, 0
  s_cselect_b32 s4, s4, s8
  s_cselect_b32 s5, 63, 31
  s_lshr_b32 s6, s2, 6
  s_lshl3_add_u32 s4, s6, s4
  s_lshl_b32 s4, s4, 7
  s_add_u32 s4, s4, 40960
  v_and_b32 v252, s5, v0
  v_lshl_add_u32 v252, v252, 2, s4
  v_mov_b32 v2, 0xdddd
  v_and_b32 v4, 15, v0
  v_lshrrev_b32 v5, 4, v0
  v_lshlrev_b32 v6, 7, v5
  v_add_u32 v6, s9, v6
  v_sub_u32 v7, 928, v6
  v_sub_u32 v250, 0x800, v6
  v_and_b32 v250, 0x7ff, v250
  v_sub_u32 v248, 15, v4
  v_cndmask_b32 v248, v4, v248, vcc
  v_lshlrev_b32 v248, 3, v248
  v_lshl_add_u32 v248, v5, 14, v248
  v_cndmask_b32 v249, v6, v7, vcc
  v_cndmask_b32 v250, v6, v250, vcc
  s_lshl_b32 s4, s8, 6
  s_add_u32 s4, s4, 896
  v_lshl_add_u32 v7, v4, 2, s4
  s_mov_b32 s4, 1792
  v_mad_u32_u24 v249, v249, s4, v7
  v_mad_u32_u24 v250, v250, s4, v7
  v_lshl_add_u32 v6, v4, 5, s9
  v_cvt_f32_u32 v6, v6
  v_mul_f32 v6, 973078528, v6
  v_lshlrev_b32 v7, 3, v5
  v_cvt_f32_u32 v7, v7
  v_mul_f32 v56, v6, v7
  s_mov_b32 s4, 0x42000000
  v_fma_f32 v60, v6, s4, v56
  v_add_f32 v64, v6, v56
  v_add_f32 v68, v6, v60
  v_fma_f32 v57, v6, 2.0, v56
  v_fma_f32 v61, v6, 2.0, v60
  v_fma_f32 v65, v6, 2.0, v64
  s_cmp_eq_u32 s31, 7
  s_cbranch_scc1 k_kv
  s_lshl1_add_u32 s69, s30, s71
  s_mul_i32 s69, s69, 28672
  s_lshl1_add_u32 s39, s31, s72
  s_lshl_b32 s39, s39, 9
  s_add_u32 s69, s69, s39
  s_add_u32 m0, s14, 32768
  s_mul_i32 s39, s34, s20
  s_add_u32 s39, s39, s66
  buffer_load_dwordx4 v10, s[44:47], s39 offen lds
  s_add_u32 m0, s15, 32768
  s_nop 0
  buffer_load_dwordx4 v11, s[48:51], s39 offen lds
  s_add_u32 m0, s64, 49152
  s_lshl_b32 s39, s35, 7
  s_add_u32 s39, s39, s65
  buffer_load_dwordx4 v8, s[40:43], s39 offen lds
  buffer_load_dwordx4 v9, s[40:43], s39 offen offset:1024 lds
  s_add_u32 m0, s14, 49152
  s_mul_i32 s39, s35, s20
  s_add_u32 s39, s39, s66
  buffer_load_dwordx4 v10, s[44:47], s39 offen lds
  s_add_u32 m0, s15, 49152
  s_nop 0
  buffer_load_dwordx4 v11, s[48:51], s39 offen lds
  s_waitcnt vmcnt(12)
  s_barrier
  ds_read_b128 a[0:3], v16 offset:0
  ds_read_b64_tr_b16 a[32:33], v24 offset:8192
  ds_read_b64_tr_b16 a[34:35], v24 offset:8704
  s_add_u32 m0, s64, 65536
  s_lshl_b32 s39, s36, 7
  s_add_u32 s39, s39, s65
  buffer_load_dwordx4 v8, s[40:43], s39 offen lds
  ds_read_b128 a[4:7], v17 offset:0
  ds_read_b64_tr_b16 a[36:37], v24 offset:10240
  ds_read_b64_tr_b16 a[38:39], v24 offset:10752
  buffer_load_dwordx4 v9, s[40:43], s39 offen offset:1024 lds
  ds_read_b128 a[8:11], v18 offset:0
  ds_read_b64_tr_b16 a[40:41], v24 offset:12288
  ds_read_b64_tr_b16 a[42:43], v24 offset:12800
  s_add_u32 m0, s14, 65536
  s_mul_i32 s39, s36, s20
  s_add_u32 s39, s39, s66
  buffer_load_dwordx4 v10, s[44:47], s39 offen lds
  ds_read_b128 a[12:15], v19 offset:0
  ds_read_b64_tr_b16 a[44:45], v24 offset:14336
  ds_read_b64_tr_b16 a[46:47], v24 offset:14848
  s_add_u32 m0, s15, 65536
  s_nop 0
  buffer_load_dwordx4 v11, s[48:51], s39 offen lds
  s_waitcnt vmcnt(12)
  s_barrier
  ds_read_b128 a[16:19], v16 offset:16384
  ds_read_b64_tr_b16 a[48:49], v24 offset:24576
  ds_read_b64_tr_b16 a[50:51], v24 offset:25088
  s_add_u32 m0, s64, 81920
  s_lshl_b32 s39, s37, 7
  s_add_u32 s39, s39, s65
  s_waitcnt lgkmcnt(12)
  v_mfma_f32_32x32x16_bf16 v[200:215], a[32:35], a[0:3], 0
  buffer_load_dwordx4 v8, s[40:43], s39 offen lds
  ds_read_b128 a[20:23], v17 offset:16384
  ds_read_b64_tr_b16 a[52:53], v24 offset:26624
  ds_read_b64_tr_b16 a[54:55], v24 offset:27136
  s_waitcnt lgkmcnt(12)
  v_mfma_f32_32x32x16_bf16 v[200:215], a[36:39], a[4:7], v[200:215]
  buffer_load_dwordx4 v9, s[40:43], s39 offen offset:1024 lds
  ds_read_b128 a[24:27], v18 offset:16384
  ds_read_b64_tr_b16 a[56:57], v24 offset:28672
  ds_read_b64_tr_b16 a[58:59], v24 offset:29184
  s_add_u32 m0, s14, 81920
  s_mul_i32 s39, s37, s20
  s_add_u32 s39, s39, s66
  s_waitcnt lgkmcnt(12)
  v_mfma_f32_32x32x16_bf16 v[200:215], a[40:43], a[8:11], v[200:215]
  buffer_load_dwordx4 v10, s[44:47], s39 offen lds
  ds_read_b128 a[28:31], v19 offset:16384
  ds_read_b64_tr_b16 a[60:61], v24 offset:30720
  ds_read_b64_tr_b16 a[62:63], v24 offset:31232
  s_add_u32 m0, s15, 81920
  s_waitcnt lgkmcnt(12)
  v_mfma_f32_32x32x16_bf16 v[200:215], a[44:47], a[12:15], v[200:215]
  buffer_load_dwordx4 v11, s[48:51], s39 offen lds
  s_waitcnt vmcnt(12)
  s_barrier
  ds_read_b128 a[0:3], v16 offset:32768
  ds_read_b64_tr_b16 a[32:33], v24 offset:40960
  ds_read_b64_tr_b16 a[34:35], v24 offset:41472
  s_add_u32 m0, s64, 98304
  s_lshl_b32 s39, s38, 7
  s_add_u32 s39, s39, s65
  s_waitcnt lgkmcnt(12)
  v_mfma_f32_32x32x16_bf16 v[200:215], a[48:51], a[16:19], v[200:215]
  buffer_load_dwordx4 v8, s[40:43], s39 offen lds
  ds_read_b128 a[4:7], v17 offset:32768
  ds_read_b64_tr_b16 a[36:37], v24 offset:43008
  ds_read_b64_tr_b16 a[38:39], v24 offset:43520
  s_waitcnt lgkmcnt(12)
  v_mfma_f32_32x32x16_bf16 v[200:215], a[52:55], a[20:23], v[200:215]
  buffer_load_dwordx4 v9, s[40:43], s39 offen offset:1024 lds
  ds_read_b128 a[8:11], v18 offset:32768
  ds_read_b64_tr_b16 a[40:41], v24 offset:45056
  ds_read_b64_tr_b16 a[42:43], v24 offset:45568
  s_add_u32 m0, s14, 98304
  s_mul_i32 s39, s38, s20
  s_add_u32 s39, s39, s66
  s_waitcnt lgkmcnt(12)
  v_mfma_f32_32x32x16_bf16 v[200:215], a[56:59], a[24:27], v[200:215]
  buffer_load_dwordx4 v10, s[44:47], s39 offen lds
  ds_read_b128 a[12:15], v19 offset:32768
  ds_read_b64_tr_b16 a[44:45], v24 offset:47104
  ds_read_b64_tr_b16 a[46:47], v24 offset:47616
  s_add_u32 m0, s15, 98304
  s_waitcnt lgkmcnt(12)
  v_mfma_f32_32x32x16_bf16 v[200:215], a[60:63], a[28:31], v[200:215]
  buffer_load_dwordx4 v11, s[48:51], s39 offen lds
  s_waitcnt vmcnt(12)
  s_barrier
  ds_read_b128 a[16:19], v16 offset:49152
  ds_read_b64_tr_b16 a[48:49], v24 offset:57344
  ds_read_b64_tr_b16 a[50:51], v24 offset:57856
  s_lshr_b32 s39, s2, 3
  s_lshl2_add_u32 s39, s39, s3
  v_lshrrev_b32 v14, 4, v0
  v_lshl_add_u32 v14, s39, 2, v14
  s_and_b32 s39, s2, 7
  s_mul_i32 s39, s39, 448
  v_min_u32 v14, 447, v14
  v_add_lshl_u32 v14, v14, s39, 7
  v_min_u32 v14, 401280, v14
  s_waitcnt lgkmcnt(12)
  v_mfma_f32_32x32x16_bf16 v[200:215], a[32:35], a[0:3], v[200:215]
  global_load_dword v15, v14, s[12:13]
  ds_read_b128 a[20:23], v17 offset:49152
  ds_read_b64_tr_b16 a[52:53], v24 offset:59392
  ds_read_b64_tr_b16 a[54:55], v24 offset:59904
  s_add_u32 m0, s64, 114688
  s_lshl_b32 s39, s32, 7
  s_add_u32 s39, s39, s67
  s_waitcnt lgkmcnt(12)
  v_mfma_f32_32x32x16_bf16 v[200:215], a[36:39], a[4:7], v[200:215]
  buffer_load_dwordx4 v12, s[56:59], s39 offen lds
  ds_read_b128 a[24:27], v18 offset:49152
  ds_read_b64_tr_b16 a[56:57], v24 offset:61440
  ds_read_b64_tr_b16 a[58:59], v24 offset:61952
  s_waitcnt lgkmcnt(12)
  v_mfma_f32_32x32x16_bf16 v[200:215], a[40:43], a[8:11], v[200:215]
  buffer_load_dwordx4 v13, s[56:59], s39 offen offset:1024 lds
  ds_read_b128 a[28:31], v19 offset:49152
  ds_read_b64_tr_b16 a[60:61], v24 offset:63488
  ds_read_b64_tr_b16 a[62:63], v24 offset:64000
  s_waitcnt lgkmcnt(12)
  v_mfma_f32_32x32x16_bf16 v[200:215], a[44:47], a[12:15], v[200:215]
  s_waitcnt vmcnt(11)
  s_barrier
  ds_read_b128 a[0:3], v20 offset:0
  ds_read_b64_tr_b16 a[32:33], v25 offset:8192
  ds_read_b64_tr_b16 a[34:35], v25 offset:8704
  s_waitcnt lgkmcnt(12)
  v_mfma_f32_32x32x16_bf16 v[200:215], a[48:51], a[16:19], v[200:215]
  ds_read_b128 a[4:7], v21 offset:0
  ds_read_b64_tr_b16 a[36:37], v25 offset:10240
  ds_read_b64_tr_b16 a[38:39], v25 offset:10752
  s_waitcnt lgkmcnt(12)
  v_mfma_f32_32x32x16_bf16 v[200:215], a[52:55], a[20:23], v[200:215]
  ds_read_b128 a[8:11], v22 offset:0
  ds_read_b64_tr_b16 a[40:41], v25 offset:12288
  ds_read_b64_tr_b16 a[42:43], v25 offset:12800
  s_waitcnt lgkmcnt(12)
  v_mfma_f32_32x32x16_bf16 v[200:215], a[56:59], a[24:27], v[200:215]
  ds_read_b128 a[12:15], v23 offset:0
  ds_read_b64_tr_b16 a[44:45], v25 offset:14336
  ds_read_b64_tr_b16 a[46:47], v25 offset:14848
  s_waitcnt lgkmcnt(12)
  v_mfma_f32_32x32x16_bf16 v[200:215], a[60:63], a[28:31], v[200:215]
  s_waitcnt vmcnt(7)
  s_barrier
  ds_read_b128 a[16:19], v20 offset:16384
  ds_read_b64_tr_b16 a[48:49], v25 offset:24576
  ds_read_b64_tr_b16 a[50:51], v25 offset:25088
  s_waitcnt lgkmcnt(12)
  v_mfma_f32_32x32x16_bf16 v[200:215], a[32:35], a[0:3], v[200:215]
  ds_read_b128 a[20:23], v21 offset:16384
  ds_read_b64_tr_b16 a[52:53], v25 offset:26624
  ds_read_b64_tr_b16 a[54:55], v25 offset:27136
  s_waitcnt lgkmcnt(12)
  v_mfma_f32_32x32x16_bf16 v[200:215], a[36:39], a[4:7], v[200:215]
  ds_read_b128 a[24:27], v22 offset:16384
  ds_read_b64_tr_b16 a[56:57], v25 offset:28672
  ds_read_b64_tr_b16 a[58:59], v25 offset:29184
  s_waitcnt lgkmcnt(12)
  v_mfma_f32_32x32x16_bf16 v[200:215], a[40:43], a[8:11], v[200:215]
  ds_read_b128 a[28:31], v23 offset:16384
  ds_read_b64_tr_b16 a[60:61], v25 offset:30720
  ds_read_b64_tr_b16 a[62:63], v25 offset:31232
  s_waitcnt lgkmcnt(12)
  v_mfma_f32_32x32x16_bf16 v[200:215], a[44:47], a[12:15], v[200:215]
  s_waitcnt vmcnt(3)
  s_barrier
  ds_read_b128 a[0:3], v20 offset:32768
  ds_read_b64_tr_b16 a[32:33], v25 offset:40960
  ds_read_b64_tr_b16 a[34:35], v25 offset:41472
  s_waitcnt lgkmcnt(12)
  v_mfma_f32_32x32x16_bf16 v[200:215], a[48:51], a[16:19], v[200:215]
  ds_read_b128 a[4:7], v21 offset:32768
  ds_read_b64_tr_b16 a[36:37], v25 offset:43008
  ds_read_b64_tr_b16 a[38:39], v25 offset:43520
  s_waitcnt lgkmcnt(12)
  v_mfma_f32_32x32x16_bf16 v[200:215], a[52:55], a[20:23], v[200:215]
  ds_read_b128 a[8:11], v22 offset:32768
  ds_read_b64_tr_b16 a[40:41], v25 offset:45056
  ds_read_b64_tr_b16 a[42:43], v25 offset:45568
  s_waitcnt lgkmcnt(12)
  v_mfma_f32_32x32x16_bf16 v[200:215], a[56:59], a[24:27], v[200:215]
  ds_read_b128 a[12:15], v23 offset:32768
  ds_read_b64_tr_b16 a[44:45], v25 offset:47104
  ds_read_b64_tr_b16 a[46:47], v25 offset:47616
  s_waitcnt lgkmcnt(12)
  v_mfma_f32_32x32x16_bf16 v[200:215], a[60:63], a[28:31], v[200:215]
  s_waitcnt lgkmcnt(9)
  v_mfma_f32_32x32x16_bf16 v[200:215], a[32:35], a[0:3], v[200:215]
  s_waitcnt lgkmcnt(6)
  v_mfma_f32_32x32x16_bf16 v[200:215], a[36:39], a[4:7], v[200:215]
  s_waitcnt lgkmcnt(3)
  v_mfma_f32_32x32x16_bf16 v[200:215], a[40:43], a[8:11], v[200:215]
  s_waitcnt lgkmcnt(0)
  v_mfma_f32_32x32x16_bf16 v[200:215], a[44:47], a[12:15], v[200:215]
  s_nop 11
  v_cvt_pk_bf16_f32 v48, v200, v201
  v_cvt_pk_bf16_f32 v49, v202, v203
  v_cvt_pk_bf16_f32 v50, v204, v205
  v_cvt_pk_bf16_f32 v51, v206, v207
  buffer_store_dwordx4 v[48:51], v34, s[52:55], s69 offen offset:0 sc1
  v_cvt_pk_bf16_f32 v52, v208, v209
  v_cvt_pk_bf16_f32 v53, v210, v211
  v_cvt_pk_bf16_f32 v54, v212, v213
  v_cvt_pk_bf16_f32 v55, v214, v215
  buffer_store_dwordx4 v[52:55], v34, s[52:55], s69 offen offset:256 sc1
  buffer_load_dword v35, v35, s[16:19], 0 offen sc1
k_p1b:
  s_add_u32 s39, s31, s71
  s_cmp_eq_u32 s39, 8
  s_cbranch_scc1 k_wo
  s_add_u32 m0, s64, 122880
  s_lshl_b32 s39, s33, 7
  s_add_u32 s39, s39, s67
  buffer_load_dwordx4 v12, s[56:59], s39 offen lds
  v_fma_f32 v69, v6, 2.0, v68
  v_fma_f32 v58, v6, 2.0, v57
  v_fma_f32 v62, v6, 2.0, v61
  v_fma_f32 v66, v6, 2.0, v65
  v_fma_f32 v70, v6, 2.0, v69
  v_fma_f32 v59, v6, 2.0, v58
  v_fma_f32 v63, v6, 2.0, v62
  v_fma_f32 v67, v6, 2.0, v66
  v_fma_f32 v71, v6, 2.0, v70
  v_bfe_u32 v4, v0, 3, 2
  buffer_load_dwordx4 v13, s[56:59], s39 offen offset:1024 lds
  v_mul_u32_u24 v4, 7, v4
  v_lshrrev_b32 v5, 5, v0
  v_add_u32 v4, v4, v5
  v_and_b32 v5, 7, v0
  v_lshlrev_b32 v5, 4, v5
  v_lshrrev_b32 v6, 2, v4
  v_lshl_add_u32 v7, v6, 8, v5
  v_and_b32 v6, 1, v4
  v_lshl_add_u32 v7, v6, 7, v7
  v_bfe_u32 v6, v4, 1, 1
  s_add_u32 m0, s64, 131072
  s_lshl_b32 s39, s34, 7
  s_add_u32 s39, s39, s67
  buffer_load_dwordx4 v12, s[56:59], s39 offen lds
  v_lshl_add_u32 v7, v6, 3, v7
  s_add_u32 s8, s3, 1
  s_and_b32 s4, s8, 3
  s_mul_i32 s8, s4, 1792
  s_add_u32 s8, s8, 65536
  v_add_u32 v40, s8, v7
  s_add_u32 s8, s3, 2
  s_and_b32 s5, s8, 3
  s_mul_i32 s8, s5, 1792
  s_add_u32 s8, s8, 65536
  buffer_load_dwordx4 v13, s[56:59], s39 offen offset:1024 lds
  v_add_u32 v42, s8, v7
  s_add_u32 s8, s3, 3
  s_and_b32 s6, s8, 3
  s_mul_i32 s8, s6, 1792
  s_add_u32 s8, s8, 65536
  v_add_u32 v44, s8, v7
  s_add_u32 s8, s3, 4
  s_and_b32 s7, s8, 3
  s_mul_i32 s8, s7, 1792
  s_add_u32 s8, s8, 65536
  s_add_u32 m0, s64, 139264
  s_lshl_b32 s39, s35, 7
  s_add_u32 s39, s39, s67
  buffer_load_dwordx4 v12, s[56:59], s39 offen lds
  v_add_u32 v46, s8, v7
  v_add_u32 v4, 2, v4
  v_lshrrev_b32 v6, 2, v4
  v_lshl_add_u32 v7, v6, 8, v5
  v_and_b32 v6, 1, v4
  v_lshl_add_u32 v7, v6, 7, v7
  v_bfe_u32 v6, v4, 1, 1
  v_lshl_add_u32 v7, v6, 3, v7
  s_mul_i32 s8, s4, 1792
  s_add_u32 s8, s8, 65536
  buffer_load_dwordx4 v13, s[56:59], s39 offen offset:1024 lds
  v_add_u32 v41, s8, v7
  s_mul_i32 s8, s5, 1792
  s_add_u32 s8, s8, 65536
  v_add_u32 v43, s8, v7
  s_mul_i32 s8, s6, 1792
  s_add_u32 s8, s8, 65536
  v_add_u32 v45, s8, v7
  s_mul_i32 s8, s7, 1792
  s_add_u32 s8, s8, 65536
  v_add_u32 v47, s8, v7
  s_add_u32 m0, s64, 147456
  s_lshl_b32 s39, s36, 7
  s_add_u32 s39, s39, s67
  buffer_load_dwordx4 v12, s[56:59], s39 offen lds
  s_lshl_b32 s8, s3, 11
  s_min_u32 s8, s8, 5120
  s_add_u32 s8, s8, 65536
  v_add_u32 v39, s8, v1
  s_mul_i32 s8, s3, 12288
  v_add_u32 v4, s8, v1
  s_mul_i32 s8, s6, 12288
  v_add_u32 v5, s8, v1
  s_mul_i32 s8, s5, 12288
  v_add_u32 v6, s8, v1
  buffer_load_dwordx4 v13, s[56:59], s39 offen offset:1024 lds
  s_mul_i32 s8, s4, 12288
  v_add_u32 v7, s8, v1
  v_and_b32 v104, 15, v0
  v_cvt_f32_u32 v104, v104
  v_mul_f32 v104, 1023410176, v104
  v_bfe_u32 v105, v0, 4, 2
  v_cvt_f32_u32 v105, v105
  v_mul_f32 v105, 4.0, v105
  v_mul_f32 v88, v104, v105
  v_mul_f32 v105, 4.0, v104
  s_lshl3_add_u32 s75, s30, s31
  s_lshl_b32 s75, s75, 7
  s_add_u32 s75, s75, 5242880
  v_add_lshl_u32 v34, v0, s3, 24
  s_add_u32 s20, s28, 5242880
  s_addc_u32 s21, s29, 0
  s_lshl3_add_u32 s26, s30, s31
  s_lshl_b32 s65, s3, 11
  s_min_u32 s65, s65, 5120
  s_mul_i32 s39, s26, 7168
  s_add_u32 s39, s39, s65
  s_add_u32 s22, s28, s39
  s_addc_u32 s23, s29, 0
  s_lshl_b32 s39, s3, 16
  s_add_u32 s39, s39, 2101248
  s_add_u32 s4, s28, s39
  s_addc_u32 s5, s29, 0
  s_mul_i32 s39, s3, 100352
  s_add_u32 s39, s39, 2363392
  s_add_u32 s6, s28, s39
  s_addc_u32 s7, s29, 0
  s_waitcnt vmcnt(8)
  s_cmp_lg_u32 s3, 0
  s_cbranch_scc1 k_initok
  v_cmp_ne_u32 vcc, 1, v35
  s_cbranch_vccnz k_init
k_initok:
  s_barrier
  buffer_store_dword v255, v34, s[52:55], s75 offen sc1
  s_add_u32 m0, s64, 155648
  s_lshl_b32 s39, s37, 7
  s_add_u32 s39, s39, s67
  buffer_load_dwordx4 v12, s[56:59], s39 offen lds
  v_fma_f32 v92, v105, 4.0, v88
  v_add_f32 v89, v104, v88
  v_add_f32 v93, v104, v92
  v_add_f32 v90, v104, v89
  v_add_f32 v94, v104, v93
  v_add_f32 v91, v104, v90
  v_add_f32 v95, v104, v94
  v_cos_f32 v96, v88
  v_cos_f32 v97, v89
  buffer_load_dwordx4 v13, s[56:59], s39 offen offset:1024 lds
  v_cos_f32 v98, v90
  v_cos_f32 v99, v91
  v_cos_f32 v100, v92
  v_cos_f32 v101, v93
  v_cos_f32 v102, v94
  s_add_u32 m0, s64, 0
  s_lshl_b32 s39, s38, 7
  s_add_u32 s39, s39, s67
  buffer_load_dwordx4 v12, s[56:59], s39 offen lds
  v_cos_f32 v103, v95
  v_sin_f32 v88, v88
  v_sin_f32 v89, v89
  v_sin_f32 v90, v90
  v_sin_f32 v91, v91
  buffer_load_dwordx4 v13, s[56:59], s39 offen offset:1024 lds
  v_sin_f32 v92, v92
  v_sin_f32 v93, v93
  v_sin_f32 v94, v94
  v_sin_f32 v95, v95
  v_cvt_pk_bf16_f32 v176, v96, v97
  v_cvt_pk_bf16_f32 v177, v98, v99
  ds_read_b128 a[64:67], v28 offset:0
  ds_read_b128 a[68:71], v28 offset:2048
  ds_read_b128 a[72:75], v29 offset:0
  ds_read_b128 a[76:79], v29 offset:2048
  s_waitcnt vmcnt(11)
  s_barrier
  ds_read_b128 a[80:83], v28 offset:8192
  s_waitcnt lgkmcnt(4)
  v_mfma_f32_16x16x32_bf16 v[232:235], a[64:67], v[120:123], 0
  s_and_b32 s65, s2, 7
  ds_read_b128 a[84:87], v28 offset:10240
  v_mfma_f32_16x16x32_bf16 v[236:239], a[64:67], v[124:127], 0
  s_cmp_lt_u32 s65, 7
  s_cselect_b32 s46, 3670016, 0
  ds_read_b128 a[88:91], v29 offset:8192
  s_waitcnt lgkmcnt(5)
  v_mfma_f32_16x16x32_bf16 v[240:243], a[68:71], v[120:123], 0
  s_mov_b64 s[44:45], s[24:25]
  ds_read_b128 a[92:95], v29 offset:10240
  v_mfma_f32_16x16x32_bf16 v[244:247], a[68:71], v[124:127], 0
  s_mov_b32 s47, 0x20000
  s_waitcnt lgkmcnt(5)
  v_mfma_f32_16x16x32_bf16 v[232:235], a[72:75], v[128:131], v[232:235]
  s_mov_b64 s[40:41], s[24:25]
  v_mfma_f32_16x16x32_bf16 v[236:239], a[72:75], v[132:135], v[236:239]
  s_mov_b32 s42, 3670016
  s_waitcnt lgkmcnt(4)
  v_mfma_f32_16x16x32_bf16 v[240:243], a[76:79], v[128:131], v[240:243]
  s_mov_b32 s43, 0x20000
  v_mfma_f32_16x16x32_bf16 v[244:247], a[76:79], v[132:135], v[244:247]
  s_lshl1_add_u32 s65, s65, s71
  s_waitcnt vmcnt(9)
  s_barrier
  ds_read_b128 a[64:67], v28 offset:16384
  s_waitcnt lgkmcnt(4)
  v_mfma_f32_16x16x32_bf16 v[232:235], a[80:83], v[136:139], v[232:235]
  s_min_u32 s65, s65, 13
  ds_read_b128 a[68:71], v28 offset:18432
  v_mfma_f32_16x16x32_bf16 v[236:239], a[80:83], v[140:143], v[236:239]
  s_lshl3_add_u32 s27, s3, s31
  ds_read_b128 a[72:75], v29 offset:16384
  s_waitcnt lgkmcnt(5)
  v_mfma_f32_16x16x32_bf16 v[240:243], a[84:87], v[136:139], v[240:243]
  s_lshl_b32 s27, s27, 7
  ds_read_b128 a[76:79], v29 offset:18432
  v_mfma_f32_16x16x32_bf16 v[244:247], a[84:87], v[140:143], v[244:247]
  s_lshl2_add_u32 s27, s30, s27
  s_waitcnt lgkmcnt(5)
  v_mfma_f32_16x16x32_bf16 v[232:235], a[88:91], v[144:147], v[232:235]
  s_add_u32 s27, s27, 5283840
  v_mfma_f32_16x16x32_bf16 v[236:239], a[88:91], v[148:151], v[236:239]
  s_lshl_b32 s39, s65, 4
  s_waitcnt lgkmcnt(4)
  v_mfma_f32_16x16x32_bf16 v[240:243], a[92:95], v[144:147], v[240:243]
  s_sub_u32 s68, 209, s39
  v_mfma_f32_16x16x32_bf16 v[244:247], a[92:95], v[148:151], v[244:247]
  s_cmp_ge_u32 s65, 7
  s_cselect_b32 s68, s68, s39
  s_cselect_b32 s67, -8, 0
  s_waitcnt vmcnt(7)
  s_barrier
  ds_read_b128 a[80:83], v28 offset:24576
  s_waitcnt lgkmcnt(4)
  v_mfma_f32_16x16x32_bf16 v[232:235], a[64:67], v[152:155], v[232:235]
  s_lshr_b32 s39, s2, 3
  ds_read_b128 a[84:87], v28 offset:26624
  v_mfma_f32_16x16x32_bf16 v[236:239], a[64:67], v[156:159], v[236:239]
  s_lshl_b32 s39, s39, 16
  ds_read_b128 a[88:91], v29 offset:24576
  s_waitcnt lgkmcnt(5)
  v_mfma_f32_16x16x32_bf16 v[240:243], a[68:71], v[152:155], v[240:243]
  s_lshl3_add_u32 s68, s68, s39
  ds_read_b128 a[92:95], v29 offset:26624
  v_mfma_f32_16x16x32_bf16 v[244:247], a[68:71], v[156:159], v[244:247]
  s_add_u32 s68, s68, 3149824
  s_waitcnt lgkmcnt(5)
  v_mfma_f32_16x16x32_bf16 v[232:235], a[72:75], v[160:163], v[232:235]
  s_add_u32 s67, s67, s68
  v_mfma_f32_16x16x32_bf16 v[236:239], a[72:75], v[164:167], v[236:239]
  s_add_u32 s67, s67, 1024
  s_waitcnt lgkmcnt(4)
  v_mfma_f32_16x16x32_bf16 v[240:243], a[76:79], v[160:163], v[240:243]
  s_add_u32 s8, s28, s68
  s_addc_u32 s9, s29, 0
  v_mfma_f32_16x16x32_bf16 v[244:247], a[76:79], v[164:167], v[244:247]
  s_add_u32 s10, s28, s67
  s_addc_u32 s11, s29, 0
  s_waitcnt vmcnt(5)
  s_barrier
  ds_read_b128 a[64:67], v28 offset:32768
  s_waitcnt lgkmcnt(4)
  v_mfma_f32_16x16x32_bf16 v[232:235], a[80:83], v[168:171], v[232:235]
  s_add_u32 s12, s8, 8192
  s_addc_u32 s13, s9, 0
  ds_read_b128 a[68:71], v28 offset:34816
  v_mfma_f32_16x16x32_bf16 v[236:239], a[80:83], v[172:175], v[236:239]
  s_add_u32 s14, s10, 8192
  s_addc_u32 s15, s11, 0
  ds_read_b128 a[72:75], v29 offset:32768
  s_waitcnt lgkmcnt(5)
  v_mfma_f32_16x16x32_bf16 v[240:243], a[84:87], v[168:171], v[240:243]
  s_cmp_ge_u32 s65, 7
  s_cselect_b32 s64, -1, 1
  s_cselect_b32 s66, 2007040, 0
  ds_read_b128 a[76:79], v29 offset:34816
  v_mfma_f32_16x16x32_bf16 v[244:247], a[84:87], v[172:175], v[244:247]
  s_mul_i32 s39, s64, 57344
  s_waitcnt lgkmcnt(5)
  v_mfma_f32_16x16x32_bf16 v[200:203], a[88:91], v[120:123], 0
  s_add_u32 s57, s39, s66
  v_mfma_f32_16x16x32_bf16 v[204:207], a[88:91], v[124:127], 0
  s_mul_i32 s39, s64, 114688
  s_waitcnt lgkmcnt(4)
  v_mfma_f32_16x16x32_bf16 v[208:211], a[92:95], v[120:123], 0
  global_load_dword v253, v3, s[20:21] sc1
  s_add_u32 s58, s39, s66
  v_mfma_f32_16x16x32_bf16 v[212:215], a[92:95], v[124:127], 0
  s_mul_i32 s39, s64, 172032
  s_waitcnt vmcnt(3)
  s_barrier
  ds_read_b128 a[80:83], v28 offset:40960
  s_waitcnt lgkmcnt(4)
  v_mfma_f32_16x16x32_bf16 v[200:203], a[64:67], v[128:131], v[200:203]
  s_add_u32 s59, s39, s66
  ds_read_b128 a[84:87], v28 offset:43008
  v_mfma_f32_16x16x32_bf16 v[204:207], a[64:67], v[132:135], v[204:207]
  s_mul_i32 s39, s64, 1835008
  ds_read_b128 a[88:91], v29 offset:40960
  s_waitcnt lgkmcnt(5)
  v_mfma_f32_16x16x32_bf16 v[208:211], a[68:71], v[128:131], v[208:211]
  s_add_u32 s60, s39, s66
  ds_read_b128 a[92:95], v29 offset:43008
  v_mfma_f32_16x16x32_bf16 v[212:215], a[68:71], v[132:135], v[212:215]
  s_mul_i32 s39, s64, 1892352
  s_waitcnt lgkmcnt(5)
  v_mfma_f32_16x16x32_bf16 v[200:203], a[72:75], v[136:139], v[200:203]
  s_add_u32 s61, s39, s66
  v_mfma_f32_16x16x32_bf16 v[204:207], a[72:75], v[140:143], v[204:207]
  s_mul_i32 s39, s64, 1949696
  s_waitcnt lgkmcnt(4)
  v_mfma_f32_16x16x32_bf16 v[208:211], a[76:79], v[136:139], v[208:211]
  s_add_u32 s62, s39, s66
  v_mfma_f32_16x16x32_bf16 v[212:215], a[76:79], v[140:143], v[212:215]
  s_mul_i32 s39, s64, 2007040
  s_waitcnt vmcnt(1)
  s_barrier
  ds_read_b128 a[64:67], v26 offset:0
  s_waitcnt lgkmcnt(4)
  v_mfma_f32_16x16x32_bf16 v[200:203], a[80:83], v[144:147], v[200:203]
  s_add_u32 s63, s39, s66
  ds_read_b128 a[68:71], v26 offset:2048
  v_mfma_f32_16x16x32_bf16 v[204:207], a[80:83], v[148:151], v[204:207]
  s_bfe_u32 s69, s30, 0x20001
  ds_read_b128 a[72:75], v27 offset:0
  s_waitcnt lgkmcnt(5)
  v_mfma_f32_16x16x32_bf16 v[208:211], a[84:87], v[144:147], v[208:211]
  s_lshl2_add_u32 s69, s69, 768
  ds_read_b128 a[76:79], v27 offset:2048
  v_mfma_f32_16x16x32_bf16 v[212:215], a[84:87], v[148:151], v[212:215]
  s_lshr_b32 s39, s30, 3
  s_waitcnt lgkmcnt(5)
  v_mfma_f32_16x16x32_bf16 v[200:203], a[88:91], v[152:155], v[200:203]
  s_add_u32 s69, s69, s39
  v_mfma_f32_16x16x32_bf16 v[204:207], a[88:91], v[156:159], v[204:207]
  s_and_b32 s39, s30, 1
  s_waitcnt lgkmcnt(4)
  v_mfma_f32_16x16x32_bf16 v[208:211], a[92:95], v[152:155], v[208:211]
  s_lshl1_add_u32 s69, s69, s39
  v_mfma_f32_16x16x32_bf16 v[212:215], a[92:95], v[156:159], v[212:215]
  s_lshl4_add_u32 s69, s69, s31
  s_waitcnt lgkmcnt(3)
  v_mfma_f32_16x16x32_bf16 v[200:203], a[64:67], v[160:163], v[200:203]
  s_lshl_b32 s69, s69, 7
  v_mfma_f32_16x16x32_bf16 v[204:207], a[64:67], v[164:167], v[204:207]
  s_lshl_b32 s39, s3, 19
  s_waitcnt lgkmcnt(2)
  v_mfma_f32_16x16x32_bf16 v[208:211], a[68:71], v[160:163], v[208:211]
  s_add_u32 s69, s69, s39
  v_mfma_f32_16x16x32_bf16 v[212:215], a[68:71], v[164:167], v[212:215]
  s_add_u32 s70, s69, 262144
  s_waitcnt lgkmcnt(1)
  v_mfma_f32_16x16x32_bf16 v[200:203], a[72:75], v[168:171], v[200:203]
  v_cvt_pk_bf16_f32 v178, v100, v101
  v_mfma_f32_16x16x32_bf16 v[204:207], a[72:75], v[172:175], v[204:207]
  v_cvt_pk_bf16_f32 v179, v102, v103
  s_waitcnt lgkmcnt(0)
  v_mfma_f32_16x16x32_bf16 v[208:211], a[76:79], v[168:171], v[208:211]
  v_cvt_pk_bf16_f32 v180, v88, v89
  v_mfma_f32_16x16x32_bf16 v[212:215], a[76:79], v[172:175], v[212:215]
  v_cvt_pk_bf16_f32 v181, v90, v91
  v_cvt_pk_bf16_f32 v182, v92, v93
  v_cvt_pk_bf16_f32 v183, v94, v95
  v_xor_b32 v184, 0x80008000, v180
  v_xor_b32 v185, 0x80008000, v181
  v_xor_b32 v186, 0x80008000, v182
  v_xor_b32 v187, 0x80008000, v183
  v_xor_b32 v188, 0x80000000, v176
  v_xor_b32 v189, 0x80000000, v177
  v_xor_b32 v190, 0x80000000, v178
  v_xor_b32 v191, 0x80000000, v179
  v_xor_b32 v192, 0x80000000, v180
  v_xor_b32 v193, 0x80000000, v181
  v_xor_b32 v194, 0x80000000, v182
  v_xor_b32 v195, 0x80000000, v183
  v_xor_b32 v196, 0x80000000, v184
  v_xor_b32 v197, 0x80000000, v185
  v_xor_b32 v198, 0x80000000, v186
  v_xor_b32 v199, 0x80000000, v187
  v_cos_f32 v72, v56
  s_lshl_b32 s74, s71, 31
  s_or_b32 s74, s74, 1.0
  s_mov_b32 s75, s74
  v_pk_fma_f32 v[232:233], v[200:201], s[74:75], v[232:233]
  v_pk_fma_f32 v[234:235], v[202:203], s[74:75], v[234:235]
  v_pk_fma_f32 v[236:237], v[204:205], s[74:75], v[236:237]
  v_pk_fma_f32 v[238:239], v[206:207], s[74:75], v[238:239]
  v_pk_fma_f32 v[240:241], v[208:209], s[74:75], v[240:241]
  v_pk_fma_f32 v[242:243], v[210:211], s[74:75], v[242:243]
  v_pk_fma_f32 v[244:245], v[212:213], s[74:75], v[244:245]
  v_pk_fma_f32 v[246:247], v[214:215], s[74:75], v[246:247]
  v_cvt_pk_bf16_f32 v120, v232, v233
  v_cvt_pk_bf16_f32 v121, v234, v235
  v_cvt_pk_bf16_f32 v122, v240, v241
  v_cvt_pk_bf16_f32 v123, v242, v243
  v_cvt_pk_bf16_f32 v124, v236, v237
  v_cvt_pk_bf16_f32 v125, v238, v239
  v_cvt_pk_bf16_f32 v126, v244, v245
  v_cvt_pk_bf16_f32 v127, v246, v247
  v_mfma_f32_16x16x32_bf16 v[128:131], v[176:179], v[120:123], 0
  s_nop 0
  v_mfma_f32_16x16x32_bf16 v[132:135], v[176:179], v[124:127], 0
  v_mfma_f32_16x16x32_bf16 v[136:139], v[188:191], v[120:123], 0
  v_mfma_f32_16x16x32_bf16 v[140:143], v[188:191], v[124:127], 0
  v_mfma_f32_16x16x32_bf16 v[128:131], v[180:183], v[124:127], v[128:131]
  v_mfma_f32_16x16x32_bf16 v[132:135], v[184:187], v[120:123], v[132:135]
  v_mfma_f32_16x16x32_bf16 v[136:139], v[192:195], v[124:127], v[136:139]
  v_mfma_f32_16x16x32_bf16 v[140:143], v[196:199], v[120:123], v[140:143]
  s_nop 5
  v_cvt_pk_bf16_f32 v144, v128, v132
  ds_write_b32 v36, v144 offset:40960
  v_cvt_pk_bf16_f32 v145, v129, v133
  ds_write_b32 v36, v145 offset:41216
  v_cvt_pk_bf16_f32 v146, v130, v134
  ds_write_b32 v36, v146 offset:41472
  v_cvt_pk_bf16_f32 v147, v131, v135
  ds_write_b32 v36, v147 offset:41728
  v_cvt_pk_bf16_f32 v148, v136, v140
  ds_write_b32 v36, v148 offset:45056
  v_cvt_pk_bf16_f32 v149, v137, v141
  ds_write_b32 v36, v149 offset:45312
  v_cvt_pk_bf16_f32 v150, v138, v142
  ds_write_b32 v36, v150 offset:45568
  v_cvt_pk_bf16_f32 v151, v139, v143
  ds_write_b32 v36, v151 offset:45824
  v_sin_f32 v56, v56
  v_cos_f32 v73, v57
  v_sin_f32 v57, v57
  v_cos_f32 v74, v58
  v_sin_f32 v58, v58
  v_cos_f32 v75, v59
  v_sin_f32 v59, v59
  v_cos_f32 v76, v60
  v_sin_f32 v60, v60
  v_cos_f32 v77, v61
  v_sin_f32 v61, v61
  v_cos_f32 v78, v62
  v_sin_f32 v62, v62
  v_cos_f32 v79, v63
  v_sin_f32 v63, v63
  v_cos_f32 v80, v64
  v_sin_f32 v64, v64
  v_cos_f32 v81, v65
  v_sin_f32 v65, v65
  v_cos_f32 v82, v66
  v_sin_f32 v66, v66
  v_cos_f32 v83, v67
  v_sin_f32 v67, v67
  v_cos_f32 v84, v68
  v_sin_f32 v68, v68
  v_cos_f32 v85, v69
  v_sin_f32 v69, v69
  v_cos_f32 v86, v70
  v_sin_f32 v70, v70
  v_cos_f32 v87, v71
  v_sin_f32 v71, v71
  v_cvt_pk_bf16_f32 v216, v72, v56
  v_cvt_pk_bf16_f32 v217, v73, v57
  v_cvt_pk_bf16_f32 v218, v74, v58
  v_cvt_pk_bf16_f32 v219, v75, v59
  v_cvt_pk_bf16_f32 v220, v76, v60
  v_cvt_pk_bf16_f32 v221, v77, v61
  v_cvt_pk_bf16_f32 v222, v78, v62
  v_cvt_pk_bf16_f32 v223, v79, v63
  v_cvt_pk_bf16_f32 v224, v80, v64
  v_cvt_pk_bf16_f32 v225, v81, v65
  v_cvt_pk_bf16_f32 v226, v82, v66
  v_cvt_pk_bf16_f32 v227, v83, v67
  v_cvt_pk_bf16_f32 v228, v84, v68
  s_waitcnt vmcnt(0)
  v_cmp_ne_u32 vcc, 1, v253
  s_cbranch_vccz k_poll_ok
k_poll:
  s_mov_b32 s73, 0
k_poll_l:
  global_load_dword v253, v3, s[20:21] sc1
  s_add_u32 s73, s73, 1
  s_cmp_gt_u32 s73, 20000
  s_waitcnt vmcnt(0)
  s_cbranch_scc1 k_poll_ok
  v_cmp_ne_u32 vcc, 1, v253
  s_cbranch_vccnz k_poll_l
  s_branch k_poll_ok
k_poll_ok:
  global_load_dwordx4 v[48:51], v1, s[22:23] offset:0 sc1
  global_load_dwordx4 v[52:55], v1, s[22:23] offset:1024 sc1
  global_load_dwordx4 v[152:155], v1, s[4:5] offset:-4096 sc1
  global_load_dwordx4 v[156:159], v1, s[4:5] offset:-3072 sc1
  global_load_dwordx4 v[160:163], v1, s[4:5] offset:-2048 sc1
  global_load_dwordx4 v[164:167], v1, s[4:5] offset:-1024 sc1
  global_load_dwordx4 v[168:171], v1, s[4:5] offset:0 sc1
  global_load_dwordx4 v[172:175], v1, s[4:5] offset:1024 sc1
  v_mov_b32 v3, v37
  v_cvt_pk_bf16_f32 v229, v85, v69
  v_cvt_pk_bf16_f32 v230, v86, v70
  v_cvt_pk_bf16_f32 v231, v87, v71
  v_mov_b64 v[56:57], 0
  v_mov_b64 v[58:59], 0
  v_mov_b64 v[60:61], 0
  v_mov_b64 v[62:63], 0
  v_mov_b64 v[64:65], 0
  v_mov_b64 v[66:67], 0
  v_mov_b64 v[68:69], 0
  v_mov_b64 v[70:71], 0
  v_mov_b64 v[72:73], 0
  v_mov_b64 v[74:75], 0
  v_mov_b64 v[76:77], 0
  v_mov_b64 v[78:79], 0
  v_mov_b64 v[80:81], 0
  v_mov_b64 v[82:83], 0
  v_mov_b64 v[84:85], 0
  v_mov_b64 v[86:87], 0
  v_mov_b64 v[88:89], 0
  v_mov_b64 v[90:91], 0
  v_mov_b64 v[92:93], 0
  v_mov_b64 v[94:95], 0
  v_mov_b64 v[96:97], 0
  v_mov_b64 v[98:99], 0
  v_mov_b64 v[100:101], 0
  v_mov_b64 v[102:103], 0
  v_mov_b64 v[104:105], 0
  v_mov_b64 v[106:107], 0
  v_mov_b64 v[108:109], 0
  v_mov_b64 v[110:111], 0
  v_mov_b64 v[112:113], 0
  v_mov_b64 v[114:115], 0
  v_mov_b64 v[116:117], 0
  v_mov_b64 v[118:119], 0
k_join:
  s_mov_b32 s36, 0
  v_mov_b32 v126, 49792
  v_mov_b32 v127, 0
  v_mov_b32 v134, 49792
  v_mov_b32 v135, 0
  v_mov_b32 v142, 49792
  v_mov_b32 v143, 0
  v_mov_b32 v150, 49792
  v_mov_b32 v151, 0
k_restart:
  s_waitcnt vmcnt(7)
  ds_write_b128 v39, v[48:51] offset:0
  s_waitcnt vmcnt(6)
  ds_write_b128 v39, v[52:55] offset:1024
  s_waitcnt lgkmcnt(0)
  s_barrier
  ds_read_b64 v[120:121], v40 offset:0
  ds_read_b64 v[122:123], v41 offset:0
  ds_read_b64 v[124:125], v40 offset:256
  s_mov_b32 exec_hi, 0
  ds_read_b64 v[126:127], v41 offset:256
  ds_read_b64 v[134:135], v43 offset:256
  ds_read_b64 v[142:143], v45 offset:256
  ds_read_b64 v[150:151], v47 offset:256
  s_mov_b32 exec_hi, -1
  ds_read_b64 v[128:129], v42 offset:0
  ds_read_b64 v[130:131], v43 offset:0
  ds_read_b64 v[132:133], v42 offset:256
  ds_read_b64 v[136:137], v44 offset:0
  ds_read_b64 v[138:139], v45 offset:0
  ds_read_b64 v[140:141], v44 offset:256
  ds_read_b64 v[144:145], v46 offset:0
  ds_read_b64 v[146:147], v47 offset:0
  ds_read_b64 v[148:149], v46 offset:256
  ds_read_b128 v[200:203], v38 offset:40960
  ds_read_b128 v[204:207], v38 offset:41984
  s_waitcnt vmcnt(5) lgkmcnt(15)
  v_mfma_f32_32x32x16_bf16 v[8:23], v[152:155], v[120:123], 0
  s_waitcnt vmcnt(4) lgkmcnt(14)
  v_mfma_f32_32x32x16_bf16 v[8:23], v[156:159], v[124:127], v[8:23]
  s_waitcnt lgkmcnt(9)
  v_mfma_f32_32x32x16_bf16 v[24:39], v[152:155], v[128:131], 0
  global_load_dwordx4 v[176:179], v1, s[4:5] offset:2048 sc1
  s_nop 8
  v_exp_f32 v8, v8
  v_exp_f32 v9, v9
  v_exp_f32 v10, v10
  v_exp_f32 v11, v11
  s_waitcnt lgkmcnt(8)
  v_mfma_f32_32x32x16_bf16 v[24:39], v[156:159], v[132:135], v[24:39]
  global_load_dwordx4 v[180:183], v1, s[4:5] offset:3072 sc1
  v_exp_f32 v12, v12
  v_exp_f32 v13, v13
  v_exp_f32 v14, v14
  v_exp_f32 v15, v15
  s_add_u32 s4, s4, 8192
  s_waitcnt lgkmcnt(1)
  buffer_store_dwordx4 v[200:203], v3, s[52:55], s69 offen sc1
  v_exp_f32 v16, v16
  v_exp_f32 v17, v17
  v_exp_f32 v18, v18
  v_exp_f32 v19, v19
  s_waitcnt vmcnt(5)
  s_waitcnt lgkmcnt(0)
  buffer_store_dwordx4 v[204:207], v3, s[52:55], s70 offen sc1
  v_exp_f32 v20, v20
  v_exp_f32 v21, v21
  v_exp_f32 v22, v22
  v_exp_f32 v23, v23
  v_mfma_f32_32x32x16_bf16 v[40:55], v[152:155], v[136:139], 0
  s_addc_u32 s5, s5, 0
  v_exp_f32 v24, v24
  v_exp_f32 v25, v25
  v_exp_f32 v26, v26
  v_exp_f32 v27, v27
  v_mfma_f32_32x32x16_bf16 v[40:55], v[156:159], v[140:143], v[40:55]
  global_load_dwordx4 v[184:187], v1, s[4:5] offset:-4096 sc1
  v_exp_f32 v28, v28
  v_exp_f32 v29, v29
  v_exp_f32 v30, v30
  v_exp_f32 v31, v31
  v_smfmac_f32_32x32x32_bf16 v[56:71], v[160:163], v[8:15], v2
  global_load_dwordx4 v[188:191], v1, s[4:5] offset:-3072 sc1
  v_exp_f32 v32, v32
  v_exp_f32 v33, v33
  v_exp_f32 v34, v34
  v_exp_f32 v35, v35
  v_smfmac_f32_32x32x32_bf16 v[56:71], v[164:167], v[16:23], v2
  v_exp_f32 v36, v36
  v_exp_f32 v37, v37
  v_exp_f32 v38, v38
  v_exp_f32 v39, v39
  v_mfma_f32_32x32x16_bf16 v[8:23], v[152:155], v[144:147], 0
  global_load_dwordx4 v[192:195], v1, s[4:5] offset:-2048 sc1
  v_exp_f32 v40, v40
  v_exp_f32 v41, v41
  v_exp_f32 v42, v42
  v_exp_f32 v43, v43
  v_mfma_f32_32x32x16_bf16 v[8:23], v[156:159], v[148:151], v[8:23]
  global_load_dwordx4 v[196:199], v1, s[4:5] offset:-1024 sc1
  v_exp_f32 v44, v44
  v_exp_f32 v45, v45
  v_exp_f32 v46, v46
  v_exp_f32 v47, v47
  v_smfmac_f32_32x32x32_bf16 v[72:87], v[160:163], v[24:31], v2
  v_exp_f32 v48, v48
  v_exp_f32 v49, v49
  v_exp_f32 v50, v50
  v_exp_f32 v51, v51
  v_smfmac_f32_32x32x32_bf16 v[72:87], v[164:167], v[32:39], v2
  s_waitcnt vmcnt(8)
  v_exp_f32 v52, v52
  v_exp_f32 v53, v53
  v_exp_f32 v54, v54
  v_exp_f32 v55, v55
  v_mfma_f32_32x32x16_bf16 v[24:39], v[168:171], v[120:123], 0
  global_load_dwordx4 v[200:203], v1, s[4:5] offset:0 sc1
  v_exp_f32 v8, v8
  v_exp_f32 v9, v9
  v_exp_f32 v10, v10
  v_exp_f32 v11, v11
  v_mfma_f32_32x32x16_bf16 v[24:39], v[172:175], v[124:127], v[24:39]
  global_load_dwordx4 v[204:207], v1, s[4:5] offset:1024 sc1
  v_exp_f32 v12, v12
  v_exp_f32 v13, v13
  v_exp_f32 v14, v14
  v_exp_f32 v15, v15
  v_smfmac_f32_32x32x32_bf16 v[88:103], v[160:163], v[40:47], v2
  v_exp_f32 v16, v16
  v_exp_f32 v17, v17
  v_exp_f32 v18, v18
  v_exp_f32 v19, v19
  v_smfmac_f32_32x32x32_bf16 v[88:103], v[164:167], v[48:55], v2
  v_exp_f32 v20, v20
  v_exp_f32 v21, v21
  v_exp_f32 v22, v22
  v_exp_f32 v23, v23
  v_mfma_f32_32x32x16_bf16 v[40:55], v[168:171], v[128:131], 0
  global_load_dwordx4 v[208:211], v1, s[4:5] offset:2048 sc1
  v_exp_f32 v24, v24
  v_exp_f32 v25, v25
  v_exp_f32 v26, v26
  v_exp_f32 v27, v27
  v_mfma_f32_32x32x16_bf16 v[40:55], v[172:175], v[132:135], v[40:55]
  global_load_dwordx4 v[212:215], v1, s[4:5] offset:3072 sc1
  v_exp_f32 v28, v28
  v_exp_f32 v29, v29
  v_exp_f32 v30, v30
  v_exp_f32 v31, v31
  v_smfmac_f32_32x32x32_bf16 v[104:119], v[160:163], v[8:15], v2
  s_add_u32 s4, s4, 8192
  s_addc_u32 s5, s5, 0
  v_exp_f32 v32, v32
  v_exp_f32 v33, v33
  v_exp_f32 v34, v34
  v_exp_f32 v35, v35
  v_smfmac_f32_32x32x32_bf16 v[104:119], v[164:167], v[16:23], v2
  s_waitcnt vmcnt(10)
  v_exp_f32 v36, v36
  v_exp_f32 v37, v37
  v_exp_f32 v38, v38
  v_exp_f32 v39, v39
  v_mfma_f32_32x32x16_bf16 v[8:23], v[168:171], v[136:139], 0
  global_load_dwordx4 v[152:155], v1, s[4:5] offset:-4096 sc1
  v_exp_f32 v40, v40
  v_exp_f32 v41, v41
  v_exp_f32 v42, v42
  v_exp_f32 v43, v43
  v_mfma_f32_32x32x16_bf16 v[8:23], v[172:175], v[140:143], v[8:23]
  global_load_dwordx4 v[156:159], v1, s[4:5] offset:-3072 sc1
  v_exp_f32 v44, v44
  v_exp_f32 v45, v45
  v_exp_f32 v46, v46
  v_exp_f32 v47, v47
  v_smfmac_f32_32x32x32_bf16 v[56:71], v[176:179], v[24:31], v2
  v_exp_f32 v48, v48
  v_exp_f32 v49, v49
  v_exp_f32 v50, v50
  v_exp_f32 v51, v51
  v_smfmac_f32_32x32x32_bf16 v[56:71], v[180:183], v[32:39], v2
  v_exp_f32 v52, v52
  v_exp_f32 v53, v53
  v_exp_f32 v54, v54
  v_exp_f32 v55, v55
  v_mfma_f32_32x32x16_bf16 v[24:39], v[168:171], v[144:147], 0
  global_load_dword v253, v251, s[20:21] sc1
  v_exp_f32 v8, v8
  v_exp_f32 v9, v9
  v_exp_f32 v10, v10
  v_exp_f32 v11, v11
  v_mfma_f32_32x32x16_bf16 v[24:39], v[172:175], v[148:151], v[24:39]
  global_load_dwordx4 v[160:163], v1, s[4:5] offset:-2048 sc1
  v_exp_f32 v12, v12
  v_exp_f32 v13, v13
  v_exp_f32 v14, v14
  v_exp_f32 v15, v15
  v_smfmac_f32_32x32x32_bf16 v[72:87], v[176:179], v[40:47], v2
  global_load_dwordx4 v[164:167], v1, s[4:5] offset:-1024 sc1
  v_exp_f32 v16, v16
  v_exp_f32 v17, v17
  v_exp_f32 v18, v18
  v_exp_f32 v19, v19
  v_smfmac_f32_32x32x32_bf16 v[72:87], v[180:183], v[48:55], v2
  s_waitcnt vmcnt(11)
  v_exp_f32 v20, v20
  v_exp_f32 v21, v21
  v_exp_f32 v22, v22
  v_exp_f32 v23, v23
  v_mfma_f32_32x32x16_bf16 v[40:55], v[184:187], v[120:123], 0
  global_load_dwordx4 v[168:171], v1, s[4:5] offset:0 sc1
  v_exp_f32 v24, v24
  v_exp_f32 v25, v25
  v_exp_f32 v26, v26
  v_exp_f32 v27, v27
  v_mfma_f32_32x32x16_bf16 v[40:55], v[188:191], v[124:127], v[40:55]
  global_load_dwordx4 v[172:175], v1, s[4:5] offset:1024 sc1
  v_exp_f32 v28, v28
  v_exp_f32 v29, v29
  v_exp_f32 v30, v30
  v_exp_f32 v31, v31
  v_smfmac_f32_32x32x32_bf16 v[88:103], v[176:179], v[8:15], v2
  buffer_store_dword v255, v254, s[52:55], s27 offen sc1
  v_exp_f32 v32, v32
  v_exp_f32 v33, v33
  v_exp_f32 v34, v34
  v_exp_f32 v35, v35
  v_smfmac_f32_32x32x32_bf16 v[88:103], v[180:183], v[16:23], v2
  v_exp_f32 v36, v36
  v_exp_f32 v37, v37
  v_exp_f32 v38, v38
  v_exp_f32 v39, v39
  v_mfma_f32_32x32x16_bf16 v[8:23], v[184:187], v[128:131], 0
  v_exp_f32 v40, v40
  v_exp_f32 v41, v41
  v_exp_f32 v42, v42
  v_exp_f32 v43, v43
  v_mfma_f32_32x32x16_bf16 v[8:23], v[188:191], v[132:135], v[8:23]
  v_exp_f32 v44, v44
  v_exp_f32 v45, v45
  v_exp_f32 v46, v46
  v_exp_f32 v47, v47
  v_smfmac_f32_32x32x32_bf16 v[104:119], v[176:179], v[24:31], v2
  v_exp_f32 v48, v48
  v_exp_f32 v49, v49
  v_exp_f32 v50, v50
  v_exp_f32 v51, v51
  v_smfmac_f32_32x32x32_bf16 v[104:119], v[180:183], v[32:39], v2
  s_waitcnt vmcnt(12)
  v_exp_f32 v52, v52
  v_exp_f32 v53, v53
  v_exp_f32 v54, v54
  v_exp_f32 v55, v55
  v_mfma_f32_32x32x16_bf16 v[24:39], v[184:187], v[136:139], 0
  global_load_dwordx4 v[176:179], v1, s[4:5] offset:2048 sc1
  v_exp_f32 v8, v8
  v_exp_f32 v9, v9
  v_exp_f32 v10, v10
  v_exp_f32 v11, v11
  v_mfma_f32_32x32x16_bf16 v[24:39], v[188:191], v[140:143], v[24:39]
  global_load_dwordx4 v[180:183], v1, s[4:5] offset:3072 sc1
  v_exp_f32 v12, v12
  v_exp_f32 v13, v13
  v_exp_f32 v14, v14
  v_exp_f32 v15, v15
  v_smfmac_f32_32x32x32_bf16 v[56:71], v[192:195], v[40:47], v2
  s_waitcnt vmcnt(7)
  s_add_u32 s4, s4, 8192
  v_exp_f32 v16, v16
  v_cmp_ne_u32 vcc, 1, v253
  v_exp_f32 v17, v17
  v_exp_f32 v18, v18
  v_exp_f32 v19, v19
  v_smfmac_f32_32x32x32_bf16 v[56:71], v[196:199], v[48:55], v2
  s_addc_u32 s5, s5, 0
  s_cbranch_vccnz k_wwait
k_wwait_ok:
  v_exp_f32 v20, v20
  v_exp_f32 v21, v21
  v_exp_f32 v22, v22
  v_exp_f32 v23, v23
  v_mfma_f32_32x32x16_bf16 v[40:55], v[184:187], v[144:147], 0
  global_load_dwordx4 a[0:3], v1, s[6:7] offset:-4096 sc1
  v_exp_f32 v24, v24
  v_exp_f32 v25, v25
  v_exp_f32 v26, v26
  v_exp_f32 v27, v27
  v_mfma_f32_32x32x16_bf16 v[40:55], v[188:191], v[148:151], v[40:55]
  global_load_dwordx4 a[4:7], v1, s[6:7] offset:-3072 sc1
  v_exp_f32 v28, v28
  v_exp_f32 v29, v29
  v_exp_f32 v30, v30
  v_exp_f32 v31, v31
  v_smfmac_f32_32x32x32_bf16 v[72:87], v[192:195], v[8:15], v2
  v_exp_f32 v32, v32
  v_exp_f32 v33, v33
  v_exp_f32 v34, v34
  v_exp_f32 v35, v35
  v_smfmac_f32_32x32x32_bf16 v[72:87], v[196:199], v[16:23], v2
  v_exp_f32 v36, v36
  v_exp_f32 v37, v37
  v_exp_f32 v38, v38
  v_exp_f32 v39, v39
  v_mfma_f32_32x32x16_bf16 v[8:23], v[200:203], v[120:123], 0
  global_load_dwordx4 v[184:187], v1, s[4:5] offset:-4096 sc1
  v_exp_f32 v40, v40
  v_exp_f32 v41, v41
  v_exp_f32 v42, v42
  v_exp_f32 v43, v43
  v_mfma_f32_32x32x16_bf16 v[8:23], v[204:207], v[124:127], v[8:23]
  global_load_dwordx4 v[188:191], v1, s[4:5] offset:-3072 sc1
  v_exp_f32 v44, v44
  v_exp_f32 v45, v45
  v_exp_f32 v46, v46
  v_exp_f32 v47, v47
  v_smfmac_f32_32x32x32_bf16 v[88:103], v[192:195], v[24:31], v2
  global_load_dwordx4 a[8:11], v1, s[6:7] offset:-2048 sc1
  v_exp_f32 v48, v48
  v_exp_f32 v49, v49
  v_exp_f32 v50, v50
  v_exp_f32 v51, v51
  v_smfmac_f32_32x32x32_bf16 v[88:103], v[196:199], v[32:39], v2
  v_exp_f32 v52, v52
  v_exp_f32 v53, v53
  v_exp_f32 v54, v54
  v_exp_f32 v55, v55
  v_mfma_f32_32x32x16_bf16 v[24:39], v[200:203], v[128:131], 0
  global_load_dwordx4 a[12:15], v1, s[6:7] offset:-1024 sc1
  v_exp_f32 v8, v8
  v_exp_f32 v9, v9
  v_exp_f32 v10, v10
  v_exp_f32 v11, v11
  v_mfma_f32_32x32x16_bf16 v[24:39], v[204:207], v[132:135], v[24:39]
  global_load_dwordx4 a[16:19], v1, s[6:7] offset:0 sc1
  v_exp_f32 v12, v12
  v_exp_f32 v13, v13
  v_exp_f32 v14, v14
  v_exp_f32 v15, v15
  v_smfmac_f32_32x32x32_bf16 v[104:119], v[192:195], v[40:47], v2
  global_load_dwordx4 a[20:23], v1, s[6:7] offset:1024 sc1
  v_exp_f32 v16, v16
  v_exp_f32 v17, v17
  v_exp_f32 v18, v18
  v_exp_f32 v19, v19
  v_smfmac_f32_32x32x32_bf16 v[104:119], v[196:199], v[48:55], v2
  v_exp_f32 v20, v20
  v_exp_f32 v21, v21
  v_exp_f32 v22, v22
  v_exp_f32 v23, v23
  v_mfma_f32_32x32x16_bf16 v[40:55], v[200:203], v[136:139], 0
  global_load_dwordx4 v[192:195], v1, s[4:5] offset:-2048 sc1
  v_exp_f32 v24, v24
  v_exp_f32 v25, v25
  v_exp_f32 v26, v26
  v_exp_f32 v27, v27
  v_mfma_f32_32x32x16_bf16 v[40:55], v[204:207], v[140:143], v[40:55]
  global_load_dwordx4 v[196:199], v1, s[4:5] offset:-1024 sc1
  v_exp_f32 v28, v28
  v_exp_f32 v29, v29
  v_exp_f32 v30, v30
  v_exp_f32 v31, v31
  v_smfmac_f32_32x32x32_bf16 v[56:71], v[208:211], v[8:15], v2
  v_exp_f32 v32, v32
  v_exp_f32 v33, v33
  v_exp_f32 v34, v34
  v_exp_f32 v35, v35
  v_smfmac_f32_32x32x32_bf16 v[56:71], v[212:215], v[16:23], v2
  v_exp_f32 v36, v36
  v_exp_f32 v37, v37
  v_exp_f32 v38, v38
  v_exp_f32 v39, v39
  v_mfma_f32_32x32x16_bf16 v[8:23], v[200:203], v[144:147], 0
  global_load_dwordx4 a[24:27], v1, s[6:7] offset:2048 sc1
  v_exp_f32 v40, v40
  v_exp_f32 v41, v41
  v_exp_f32 v42, v42
  v_exp_f32 v43, v43
  v_mfma_f32_32x32x16_bf16 v[8:23], v[204:207], v[148:151], v[8:23]
  global_load_dwordx4 a[28:31], v1, s[6:7] offset:3072 sc1
  v_exp_f32 v44, v44
  v_exp_f32 v45, v45
  v_exp_f32 v46, v46
  v_exp_f32 v47, v47
  v_smfmac_f32_32x32x32_bf16 v[72:87], v[208:211], v[24:31], v2
  s_add_u32 s6, s6, 8192
  s_addc_u32 s7, s7, 0
  v_exp_f32 v48, v48
  v_exp_f32 v49, v49
  v_exp_f32 v50, v50
  v_exp_f32 v51, v51
  v_smfmac_f32_32x32x32_bf16 v[72:87], v[212:215], v[32:39], v2
  global_load_dwordx4 a[32:35], v1, s[6:7] offset:-4096 sc1
  v_exp_f32 v52, v52
  v_exp_f32 v53, v53
  v_exp_f32 v54, v54
  v_exp_f32 v55, v55
  v_mfma_f32_32x32x16_bf16 v[24:39], v[152:155], v[120:123], 0
  global_load_dwordx4 v[200:203], v1, s[4:5] offset:0 sc1
  v_exp_f32 v8, v8
  v_exp_f32 v9, v9
  v_exp_f32 v10, v10
  v_exp_f32 v11, v11
  v_mfma_f32_32x32x16_bf16 v[24:39], v[156:159], v[124:127], v[24:39]
  global_load_dwordx4 v[204:207], v1, s[4:5] offset:1024 sc1
  v_exp_f32 v12, v12
  v_exp_f32 v13, v13
  v_exp_f32 v14, v14
  v_exp_f32 v15, v15
  v_smfmac_f32_32x32x32_bf16 v[88:103], v[208:211], v[40:47], v2
  v_exp_f32 v16, v16
  v_exp_f32 v17, v17
  v_exp_f32 v18, v18
  v_exp_f32 v19, v19
  v_smfmac_f32_32x32x32_bf16 v[88:103], v[212:215], v[48:55], v2
  v_exp_f32 v20, v20
  v_exp_f32 v21, v21
  v_exp_f32 v22, v22
  v_exp_f32 v23, v23
  v_mfma_f32_32x32x16_bf16 v[40:55], v[152:155], v[128:131], 0
  global_load_dwordx4 a[36:39], v1, s[6:7] offset:-3072 sc1
  v_exp_f32 v24, v24
  v_exp_f32 v25, v25
  v_exp_f32 v26, v26
  v_exp_f32 v27, v27
  v_mfma_f32_32x32x16_bf16 v[40:55], v[156:159], v[132:135], v[40:55]
  global_load_dwordx4 a[40:43], v1, s[6:7] offset:-2048 sc1
  v_exp_f32 v28, v28
  v_exp_f32 v29, v29
  v_exp_f32 v30, v30
  v_exp_f32 v31, v31
  v_smfmac_f32_32x32x32_bf16 v[104:119], v[208:211], v[8:15], v2
  global_load_dwordx4 a[44:47], v1, s[6:7] offset:-1024 sc1
  v_exp_f32 v32, v32
  v_exp_f32 v33, v33
  v_exp_f32 v34, v34
  v_exp_f32 v35, v35
  v_smfmac_f32_32x32x32_bf16 v[104:119], v[212:215], v[16:23], v2
  s_waitcnt vmcnt(23)
  v_exp_f32 v36, v36
  v_exp_f32 v37, v37
  v_exp_f32 v38, v38
  v_exp_f32 v39, v39
  v_mfma_f32_32x32x16_bf16 v[8:23], v[152:155], v[136:139], 0
  global_load_dwordx4 v[208:211], v1, s[4:5] offset:2048 sc1
  v_exp_f32 v40, v40
  v_exp_f32 v41, v41
  v_exp_f32 v42, v42
  v_exp_f32 v43, v43
  v_mfma_f32_32x32x16_bf16 v[8:23], v[156:159], v[140:143], v[8:23]
  global_load_dwordx4 v[212:215], v1, s[4:5] offset:3072 sc1
  v_exp_f32 v44, v44
  v_exp_f32 v45, v45
  v_exp_f32 v46, v46
  v_exp_f32 v47, v47
  v_smfmac_f32_32x32x32_bf16 v[56:71], v[160:163], v[24:31], v2
  s_add_u32 s4, s4, 8192
  s_addc_u32 s5, s5, 0
  v_exp_f32 v48, v48
  v_exp_f32 v49, v49
  v_exp_f32 v50, v50
  v_exp_f32 v51, v51
  v_smfmac_f32_32x32x32_bf16 v[56:71], v[164:167], v[32:39], v2
  v_exp_f32 v52, v52
  v_exp_f32 v53, v53
  v_exp_f32 v54, v54
  v_exp_f32 v55, v55
  v_mfma_f32_32x32x16_bf16 v[24:39], v[152:155], v[144:147], 0
  global_load_dword v253, v252, s[20:21] sc1
  v_exp_f32 v8, v8
  v_exp_f32 v9, v9
  v_exp_f32 v10, v10
  v_exp_f32 v11, v11
  v_mfma_f32_32x32x16_bf16 v[24:39], v[156:159], v[148:151], v[24:39]
  global_load_dwordx4 a[48:51], v1, s[6:7] offset:0 sc1
  v_exp_f32 v12, v12
  v_exp_f32 v13, v13
  v_exp_f32 v14, v14
  v_exp_f32 v15, v15
  v_smfmac_f32_32x32x32_bf16 v[72:87], v[160:163], v[40:47], v2
  global_load_dwordx4 a[52:55], v1, s[6:7] offset:1024 sc1
  v_exp_f32 v16, v16
  v_exp_f32 v17, v17
  v_exp_f32 v18, v18
  v_exp_f32 v19, v19
  v_smfmac_f32_32x32x32_bf16 v[72:87], v[164:167], v[48:55], v2
  s_waitcnt vmcnt(26)
  global_load_dwordx4 a[56:59], v1, s[6:7] offset:2048 sc1
  v_exp_f32 v20, v20
  v_exp_f32 v21, v21
  v_exp_f32 v22, v22
  v_exp_f32 v23, v23
  v_mfma_f32_32x32x16_bf16 v[40:55], v[168:171], v[120:123], 0
  global_load_dwordx4 v[152:155], v1, s[4:5] offset:-4096 sc1
  v_exp_f32 v24, v24
  v_exp_f32 v25, v25
  v_exp_f32 v26, v26
  v_exp_f32 v27, v27
  v_mfma_f32_32x32x16_bf16 v[40:55], v[172:175], v[124:127], v[40:55]
  global_load_dwordx4 v[156:159], v1, s[4:5] offset:-3072 sc1
  v_exp_f32 v28, v28
  v_exp_f32 v29, v29
  v_exp_f32 v30, v30
  v_exp_f32 v31, v31
  v_smfmac_f32_32x32x32_bf16 v[88:103], v[160:163], v[8:15], v2
  v_exp_f32 v32, v32
  v_exp_f32 v33, v33
  v_exp_f32 v34, v34
  v_exp_f32 v35, v35
  v_smfmac_f32_32x32x32_bf16 v[88:103], v[164:167], v[16:23], v2
  v_exp_f32 v36, v36
  v_exp_f32 v37, v37
  v_exp_f32 v38, v38
  v_exp_f32 v39, v39
  v_mfma_f32_32x32x16_bf16 v[8:23], v[168:171], v[128:131], 0
  global_load_dwordx4 a[60:63], v1, s[6:7] offset:3072 sc1
  v_exp_f32 v40, v40
  v_exp_f32 v41, v41
  v_exp_f32 v42, v42
  v_exp_f32 v43, v43
  v_mfma_f32_32x32x16_bf16 v[8:23], v[172:175], v[132:135], v[8:23]
  s_add_u32 s6, s6, 8192
  v_exp_f32 v44, v44
  v_exp_f32 v45, v45
  v_exp_f32 v46, v46
  v_exp_f32 v47, v47
  v_smfmac_f32_32x32x32_bf16 v[104:119], v[160:163], v[24:31], v2
  s_addc_u32 s7, s7, 0
  global_load_dwordx4 a[64:67], v1, s[6:7] offset:-4096 sc1
  v_exp_f32 v48, v48
  v_exp_f32 v49, v49
  v_exp_f32 v50, v50
  v_exp_f32 v51, v51
  v_smfmac_f32_32x32x32_bf16 v[104:119], v[164:167], v[32:39], v2
  s_waitcnt vmcnt(28)
  global_load_dwordx4 a[68:71], v1, s[6:7] offset:-3072 sc1
  v_exp_f32 v52, v52
  v_exp_f32 v53, v53
  v_exp_f32 v54, v54
  v_exp_f32 v55, v55
  v_mfma_f32_32x32x16_bf16 v[24:39], v[168:171], v[136:139], 0
  global_load_dwordx4 v[160:163], v1, s[4:5] offset:-2048 sc1
  v_exp_f32 v8, v8
  v_exp_f32 v9, v9
  v_exp_f32 v10, v10
  v_exp_f32 v11, v11
  v_mfma_f32_32x32x16_bf16 v[24:39], v[172:175], v[140:143], v[24:39]
  global_load_dwordx4 v[164:167], v1, s[4:5] offset:-1024 sc1
  v_exp_f32 v12, v12
  v_exp_f32 v13, v13
  v_exp_f32 v14, v14
  v_exp_f32 v15, v15
  v_smfmac_f32_32x32x32_bf16 v[56:71], v[176:179], v[40:47], v2
  s_waitcnt vmcnt(10)
  v_exp_f32 v16, v16
  v_cmp_ne_u32 vcc, 1, v253
  v_exp_f32 v17, v17
  v_exp_f32 v18, v18
  v_exp_f32 v19, v19
  v_smfmac_f32_32x32x32_bf16 v[56:71], v[180:183], v[48:55], v2
  s_cbranch_vccnz k_uwait
k_uwait_ok:
  v_exp_f32 v20, v20
  v_exp_f32 v21, v21
  v_exp_f32 v22, v22
  v_exp_f32 v23, v23
  v_mfma_f32_32x32x16_bf16 v[40:55], v[168:171], v[144:147], 0
  global_load_dwordx2 a[224:225], v248, s[8:9] offset:-4096 sc1
  v_exp_f32 v24, v24
  v_exp_f32 v25, v25
  v_exp_f32 v26, v26
  v_exp_f32 v27, v27
  v_mfma_f32_32x32x16_bf16 v[40:55], v[172:175], v[148:151], v[40:55]
  global_load_dwordx2 a[226:227], v248, s[8:9] offset:-2048 sc1
  v_exp_f32 v28, v28
  v_exp_f32 v29, v29
  v_exp_f32 v30, v30
  v_exp_f32 v31, v31
  v_smfmac_f32_32x32x32_bf16 v[72:87], v[176:179], v[8:15], v2
  global_load_dwordx2 a[228:229], v248, s[10:11] offset:-4096 sc1
  v_exp_f32 v32, v32
  v_exp_f32 v33, v33
  v_exp_f32 v34, v34
  v_exp_f32 v35, v35
  v_smfmac_f32_32x32x32_bf16 v[72:87], v[180:183], v[16:23], v2
  global_load_dwordx2 a[230:231], v248, s[10:11] offset:-2048 sc1
  v_exp_f32 v36, v36
  v_exp_f32 v37, v37
  v_exp_f32 v38, v38
  v_exp_f32 v39, v39
  v_mfma_f32_32x32x16_bf16 v[8:23], v[184:187], v[120:123], 0
  global_load_dwordx4 v[168:171], v1, s[4:5] offset:0 sc1
  v_exp_f32 v40, v40
  v_exp_f32 v41, v41
  v_exp_f32 v42, v42
  v_exp_f32 v43, v43
  v_mfma_f32_32x32x16_bf16 v[8:23], v[188:191], v[124:127], v[8:23]
  global_load_dwordx4 v[172:175], v1, s[4:5] offset:1024 sc1
  v_exp_f32 v44, v44
  v_exp_f32 v45, v45
  v_exp_f32 v46, v46
  v_exp_f32 v47, v47
  v_smfmac_f32_32x32x32_bf16 v[88:103], v[176:179], v[24:31], v2
  global_load_dwordx2 a[232:233], v248, s[8:9] offset:0 sc1
  v_exp_f32 v48, v48
  v_exp_f32 v49, v49
  v_exp_f32 v50, v50
  v_exp_f32 v51, v51
  v_smfmac_f32_32x32x32_bf16 v[88:103], v[180:183], v[32:39], v2
  global_load_dwordx2 a[234:235], v248, s[8:9] offset:2048 sc1
  v_exp_f32 v52, v52
  v_exp_f32 v53, v53
  v_exp_f32 v54, v54
  v_exp_f32 v55, v55
  v_mfma_f32_32x32x16_bf16 v[24:39], v[184:187], v[128:131], 0
  global_load_dwordx2 a[236:237], v248, s[10:11] offset:0 sc1
  v_exp_f32 v8, v8
  v_exp_f32 v9, v9
  v_exp_f32 v10, v10
  v_exp_f32 v11, v11
  v_mfma_f32_32x32x16_bf16 v[24:39], v[188:191], v[132:135], v[24:39]
  global_load_dwordx2 a[238:239], v248, s[10:11] offset:2048 sc1
  v_exp_f32 v12, v12
  v_exp_f32 v13, v13
  v_exp_f32 v14, v14
  v_exp_f32 v15, v15
  v_smfmac_f32_32x32x32_bf16 v[104:119], v[176:179], v[40:47], v2
  global_load_dwordx2 a[240:241], v248, s[12:13] offset:-4096 sc1
  v_exp_f32 v16, v16
  v_exp_f32 v17, v17
  v_exp_f32 v18, v18
  v_exp_f32 v19, v19
  v_smfmac_f32_32x32x32_bf16 v[104:119], v[180:183], v[48:55], v2
  global_load_dwordx2 a[242:243], v248, s[12:13] offset:-2048 sc1
  v_exp_f32 v20, v20
  v_exp_f32 v21, v21
  v_exp_f32 v22, v22
  v_exp_f32 v23, v23
  v_mfma_f32_32x32x16_bf16 v[40:55], v[184:187], v[136:139], 0
  global_load_dwordx4 v[176:179], v1, s[4:5] offset:2048 sc1
  v_exp_f32 v24, v24
  v_exp_f32 v25, v25
  v_exp_f32 v26, v26
  v_exp_f32 v27, v27
  v_mfma_f32_32x32x16_bf16 v[40:55], v[188:191], v[140:143], v[40:55]
  global_load_dwordx4 v[180:183], v1, s[4:5] offset:3072 sc1
  v_exp_f32 v28, v28
  v_exp_f32 v29, v29
  v_exp_f32 v30, v30
  v_exp_f32 v31, v31
  v_smfmac_f32_32x32x32_bf16 v[56:71], v[192:195], v[8:15], v2
  s_add_u32 s4, s4, 8192
  global_load_dwordx2 a[244:245], v248, s[14:15] offset:-4096 sc1
  v_exp_f32 v32, v32
  v_exp_f32 v33, v33
  v_exp_f32 v34, v34
  v_exp_f32 v35, v35
  v_smfmac_f32_32x32x32_bf16 v[56:71], v[196:199], v[16:23], v2
  s_addc_u32 s5, s5, 0
  global_load_dwordx2 a[246:247], v248, s[14:15] offset:-2048 sc1
  v_exp_f32 v36, v36
  v_exp_f32 v37, v37
  v_exp_f32 v38, v38
  v_exp_f32 v39, v39
  v_mfma_f32_32x32x16_bf16 v[8:23], v[184:187], v[144:147], 0
  global_load_dwordx2 a[248:249], v248, s[12:13] offset:0 sc1
  v_exp_f32 v40, v40
  v_exp_f32 v41, v41
  v_exp_f32 v42, v42
  v_exp_f32 v43, v43
  v_mfma_f32_32x32x16_bf16 v[8:23], v[188:191], v[148:151], v[8:23]
  global_load_dwordx2 a[250:251], v248, s[12:13] offset:2048 sc1
  v_exp_f32 v44, v44
  v_exp_f32 v45, v45
  v_exp_f32 v46, v46
  v_exp_f32 v47, v47
  v_smfmac_f32_32x32x32_bf16 v[72:87], v[192:195], v[24:31], v2
  global_load_dwordx2 a[252:253], v248, s[14:15] offset:0 sc1
  v_exp_f32 v48, v48
  v_exp_f32 v49, v49
  v_exp_f32 v50, v50
  v_exp_f32 v51, v51
  v_smfmac_f32_32x32x32_bf16 v[72:87], v[196:199], v[32:39], v2
  global_load_dwordx2 a[254:255], v248, s[14:15] offset:2048 sc1
  v_exp_f32 v52, v52
  v_exp_f32 v53, v53
  v_exp_f32 v54, v54
  v_exp_f32 v55, v55
  v_mfma_f32_32x32x16_bf16 v[24:39], v[200:203], v[120:123], 0
  global_load_dwordx4 v[184:187], v1, s[4:5] offset:-4096 sc1
  v_exp_f32 v8, v8
  v_exp_f32 v9, v9
  v_exp_f32 v10, v10
  v_exp_f32 v11, v11
  v_mfma_f32_32x32x16_bf16 v[24:39], v[204:207], v[124:127], v[24:39]
  global_load_dwordx4 v[188:191], v1, s[4:5] offset:-3072 sc1
  v_exp_f32 v12, v12
  v_exp_f32 v13, v13
  v_exp_f32 v14, v14
  v_exp_f32 v15, v15
  v_smfmac_f32_32x32x32_bf16 v[88:103], v[192:195], v[40:47], v2
  global_load_dwordx4 a[72:75], v1, s[6:7] offset:-2048 sc1
  v_exp_f32 v16, v16
  v_exp_f32 v17, v17
  v_exp_f32 v18, v18
  v_exp_f32 v19, v19
  v_smfmac_f32_32x32x32_bf16 v[88:103], v[196:199], v[48:55], v2
  global_load_dwordx4 a[76:79], v1, s[6:7] offset:-1024 sc1
  v_exp_f32 v20, v20
  v_exp_f32 v21, v21
  v_exp_f32 v22, v22
  v_exp_f32 v23, v23
  v_mfma_f32_32x32x16_bf16 v[40:55], v[200:203], v[128:131], 0
  global_load_dwordx4 a[80:83], v1, s[6:7] offset:0 sc1
  v_exp_f32 v24, v24
  v_exp_f32 v25, v25
  v_exp_f32 v26, v26
  v_exp_f32 v27, v27
  v_mfma_f32_32x32x16_bf16 v[40:55], v[204:207], v[132:135], v[40:55]
  global_load_dwordx4 a[84:87], v1, s[6:7] offset:1024 sc1
  v_exp_f32 v28, v28
  v_exp_f32 v29, v29
  v_exp_f32 v30, v30
  v_exp_f32 v31, v31
  v_smfmac_f32_32x32x32_bf16 v[104:119], v[192:195], v[8:15], v2
  global_load_dwordx4 a[88:91], v1, s[6:7] offset:2048 sc1
  v_exp_f32 v32, v32
  v_exp_f32 v33, v33
  v_exp_f32 v34, v34
  v_exp_f32 v35, v35
  v_smfmac_f32_32x32x32_bf16 v[104:119], v[196:199], v[16:23], v2
  v_exp_f32 v36, v36
  v_exp_f32 v37, v37
  v_exp_f32 v38, v38
  v_exp_f32 v39, v39
  v_mfma_f32_32x32x16_bf16 v[8:23], v[200:203], v[136:139], 0
  global_load_dwordx4 v[192:195], v1, s[4:5] offset:-2048 sc1
  v_exp_f32 v40, v40
  v_exp_f32 v41, v41
  v_exp_f32 v42, v42
  v_exp_f32 v43, v43
  v_mfma_f32_32x32x16_bf16 v[8:23], v[204:207], v[140:143], v[8:23]
  global_load_dwordx4 v[196:199], v1, s[4:5] offset:-1024 sc1
  v_exp_f32 v44, v44
  v_exp_f32 v45, v45
  v_exp_f32 v46, v46
  v_exp_f32 v47, v47
  v_smfmac_f32_32x32x32_bf16 v[56:71], v[208:211], v[24:31], v2
  s_waitcnt vmcnt(9)
  v_exp_f32 v48, v48
  v_exp_f32 v49, v49
  v_exp_f32 v50, v50
  v_exp_f32 v51, v51
  v_smfmac_f32_32x32x32_bf16 v[56:71], v[212:215], v[32:39], v2
  v_exp_f32 v52, v52
  v_exp_f32 v53, v53
  v_exp_f32 v54, v54
  v_exp_f32 v55, v55
  v_mfma_f32_32x32x16_bf16 v[24:39], v[200:203], v[144:147], 0
  global_load_dwordx4 a[92:95], v1, s[6:7] offset:3072 sc1
  v_exp_f32 v8, v8
  v_exp_f32 v9, v9
  v_exp_f32 v10, v10
  v_exp_f32 v11, v11
  v_mfma_f32_32x32x16_bf16 v[24:39], v[204:207], v[148:151], v[24:39]
  s_add_u32 s6, s6, 8192
  v_exp_f32 v12, v12
  v_exp_f32 v13, v13
  v_exp_f32 v14, v14
  v_mfma_f32_16x16x32_bf16 v[232:235], v[216:219], a[224:227], 0
  v_exp_f32 v15, v15
  v_smfmac_f32_32x32x32_bf16 v[72:87], v[208:211], v[40:47], v2
  s_addc_u32 s7, s7, 0
  global_load_dwordx4 a[96:99], v1, s[6:7] offset:-4096 sc1
  v_exp_f32 v16, v16
  v_exp_f32 v17, v17
  v_exp_f32 v18, v18
  v_exp_f32 v19, v19
  v_smfmac_f32_32x32x32_bf16 v[72:87], v[212:215], v[48:55], v2
  global_load_dwordx4 a[100:103], v1, s[6:7] offset:-3072 sc1
  v_exp_f32 v20, v20
  v_exp_f32 v21, v21
  v_exp_f32 v22, v22
  v_mfma_f32_16x16x32_bf16 v[236:239], v[216:219], a[228:231], 0
  v_exp_f32 v23, v23
  v_mfma_f32_32x32x16_bf16 v[40:55], v[152:155], v[120:123], 0
  global_load_dwordx4 v[200:203], v1, s[4:5] offset:0 sc1
  v_exp_f32 v24, v24
  v_exp_f32 v25, v25
  v_exp_f32 v26, v26
  v_exp_f32 v27, v27
  v_mfma_f32_32x32x16_bf16 v[40:55], v[156:159], v[124:127], v[40:55]
  global_load_dwordx4 v[204:207], v1, s[4:5] offset:1024 sc1
  v_exp_f32 v28, v28
  v_exp_f32 v29, v29
  v_exp_f32 v30, v30
  v_mfma_f32_16x16x32_bf16 v[232:235], v[220:223], a[232:235], v[232:235]
  v_exp_f32 v31, v31
  v_smfmac_f32_32x32x32_bf16 v[88:103], v[208:211], v[8:15], v2
  v_exp_f32 v32, v32
  v_exp_f32 v33, v33
  v_exp_f32 v34, v34
  v_exp_f32 v35, v35
  v_smfmac_f32_32x32x32_bf16 v[88:103], v[212:215], v[16:23], v2
  v_exp_f32 v36, v36
  v_exp_f32 v37, v37
  v_exp_f32 v38, v38
  v_mfma_f32_16x16x32_bf16 v[236:239], v[220:223], a[236:239], v[236:239]
  v_exp_f32 v39, v39
  v_mfma_f32_32x32x16_bf16 v[8:23], v[152:155], v[128:131], 0
  global_load_dwordx4 a[104:107], v1, s[6:7] offset:-2048 sc1
  v_exp_f32 v40, v40
  v_exp_f32 v41, v41
  v_exp_f32 v42, v42
  v_exp_f32 v43, v43
  v_mfma_f32_32x32x16_bf16 v[8:23], v[156:159], v[132:135], v[8:23]
  global_load_dwordx4 a[108:111], v1, s[6:7] offset:-1024 sc1
  v_exp_f32 v44, v44
  v_exp_f32 v45, v45
  v_exp_f32 v46, v46
  v_mfma_f32_16x16x32_bf16 v[240:243], v[224:227], a[240:243], 0
  v_exp_f32 v47, v47
  v_smfmac_f32_32x32x32_bf16 v[104:119], v[208:211], v[24:31], v2
  global_load_dwordx4 a[112:115], v1, s[6:7] offset:0 sc1
  v_exp_f32 v48, v48
  v_exp_f32 v49, v49
  v_exp_f32 v50, v50
  v_exp_f32 v51, v51
  v_smfmac_f32_32x32x32_bf16 v[104:119], v[212:215], v[32:39], v2
  v_exp_f32 v52, v52
  v_exp_f32 v53, v53
  v_exp_f32 v54, v54
  v_mfma_f32_16x16x32_bf16 v[244:247], v[224:227], a[244:247], 0
  v_exp_f32 v55, v55
  v_mfma_f32_32x32x16_bf16 v[24:39], v[152:155], v[136:139], 0
  global_load_dwordx4 v[208:211], v1, s[4:5] offset:2048 sc1
  v_exp_f32 v8, v8
  v_exp_f32 v9, v9
  v_exp_f32 v10, v10
  v_exp_f32 v11, v11
  v_mfma_f32_32x32x16_bf16 v[24:39], v[156:159], v[140:143], v[24:39]
  global_load_dwordx4 v[212:215], v1, s[4:5] offset:3072 sc1
  v_exp_f32 v12, v12
  v_exp_f32 v13, v13
  v_exp_f32 v14, v14
  v_mfma_f32_16x16x32_bf16 v[240:243], v[228:231], a[248:251], v[240:243]
  v_exp_f32 v15, v15
  v_smfmac_f32_32x32x32_bf16 v[56:71], v[160:163], v[40:47], v2
  s_add_u32 s4, s4, 8192
  s_addc_u32 s5, s5, 0
  v_exp_f32 v16, v16
  v_exp_f32 v17, v17
  v_exp_f32 v18, v18
  v_exp_f32 v19, v19
  v_smfmac_f32_32x32x32_bf16 v[56:71], v[164:167], v[48:55], v2
  v_exp_f32 v20, v20
  v_exp_f32 v21, v21
  v_exp_f32 v22, v22
  v_mfma_f32_16x16x32_bf16 v[244:247], v[228:231], a[252:255], v[244:247]
  v_exp_f32 v23, v23
  v_mfma_f32_32x32x16_bf16 v[40:55], v[152:155], v[144:147], 0
  global_load_dwordx4 a[116:119], v1, s[6:7] offset:1024 sc1
  v_exp_f32 v24, v24
  v_exp_f32 v25, v25
  v_exp_f32 v26, v26
  v_exp_f32 v27, v27
  v_mfma_f32_32x32x16_bf16 v[40:55], v[156:159], v[148:151], v[40:55]
  global_load_dwordx4 a[120:123], v1, s[6:7] offset:2048 sc1
  v_exp_f32 v28, v28
  v_exp_f32 v29, v29
  v_exp_f32 v30, v30
  v_exp_f32 v31, v31
  v_smfmac_f32_32x32x32_bf16 v[72:87], v[160:163], v[8:15], v2
  global_load_dwordx4 a[124:127], v1, s[6:7] offset:3072 sc1
  v_exp_f32 v32, v32
  v_pk_add_f32 v[216:217], v[232:233], v[240:241]
  v_pk_add_f32 v[224:225], v[232:233], v[240:241] neg_lo:[0,1] neg_hi:[0,1]
  v_exp_f32 v33, v33
  v_exp_f32 v34, v34
  v_exp_f32 v35, v35
  v_smfmac_f32_32x32x32_bf16 v[72:87], v[164:167], v[16:23], v2
  s_add_u32 s6, s6, 8192
  s_addc_u32 s7, s7, 0
  v_exp_f32 v36, v36
  v_pk_add_f32 v[218:219], v[234:235], v[242:243]
  v_pk_add_f32 v[226:227], v[234:235], v[242:243] neg_lo:[0,1] neg_hi:[0,1]
  v_exp_f32 v37, v37
  v_exp_f32 v38, v38
  v_exp_f32 v39, v39
  v_mfma_f32_32x32x16_bf16 v[8:23], v[168:171], v[120:123], 0
  global_load_dwordx4 v[152:155], v1, s[4:5] offset:-4096 sc1
  v_exp_f32 v40, v40
  v_pk_add_f32 v[220:221], v[236:237], v[244:245]
  v_pk_add_f32 v[228:229], v[236:237], v[244:245] neg_lo:[0,1] neg_hi:[0,1]
  v_exp_f32 v41, v41
  v_exp_f32 v42, v42
  v_exp_f32 v43, v43
  v_mfma_f32_32x32x16_bf16 v[8:23], v[172:175], v[124:127], v[8:23]
  global_load_dwordx4 v[156:159], v1, s[4:5] offset:-3072 sc1
  v_exp_f32 v44, v44
  v_pk_add_f32 v[222:223], v[238:239], v[246:247]
  v_pk_add_f32 v[230:231], v[238:239], v[246:247] neg_lo:[0,1] neg_hi:[0,1]
  v_exp_f32 v45, v45
  v_exp_f32 v46, v46
  v_exp_f32 v47, v47
  v_smfmac_f32_32x32x32_bf16 v[88:103], v[160:163], v[24:31], v2
  v_exp_f32 v48, v48
  v_cvt_pk_bf16_f32 v232, v216, v220
  v_exp_f32 v49, v49
  v_exp_f32 v50, v50
  v_exp_f32 v51, v51
  v_smfmac_f32_32x32x32_bf16 v[88:103], v[164:167], v[32:39], v2
  v_exp_f32 v52, v52
  v_cvt_pk_bf16_f32 v233, v217, v221
  v_exp_f32 v53, v53
  v_exp_f32 v54, v54
  v_exp_f32 v55, v55
  v_mfma_f32_32x32x16_bf16 v[24:39], v[168:171], v[128:131], 0
  buffer_store_dword v232, v250, s[44:47], 0 offen sc1
  v_exp_f32 v8, v8
  v_exp_f32 v9, v9
  v_exp_f32 v10, v10
  v_exp_f32 v11, v11
  v_mfma_f32_32x32x16_bf16 v[24:39], v[172:175], v[132:135], v[24:39]
  buffer_store_dword v233, v249, s[44:47], s57 offen sc1
  v_exp_f32 v12, v12
  v_exp_f32 v13, v13
  v_exp_f32 v14, v14
  v_exp_f32 v15, v15
  v_smfmac_f32_32x32x32_bf16 v[104:119], v[160:163], v[40:47], v2
  global_load_dwordx4 a[128:131], v1, s[6:7] offset:-4096 sc1
  v_exp_f32 v16, v16
  v_cvt_pk_bf16_f32 v234, v218, v222
  v_exp_f32 v17, v17
  v_exp_f32 v18, v18
  v_exp_f32 v19, v19
  v_smfmac_f32_32x32x32_bf16 v[104:119], v[164:167], v[48:55], v2
  global_load_dwordx4 a[132:135], v1, s[6:7] offset:-3072 sc1
  v_exp_f32 v20, v20
  v_cvt_pk_bf16_f32 v235, v219, v223
  v_exp_f32 v21, v21
  v_exp_f32 v22, v22
  v_exp_f32 v23, v23
  v_mfma_f32_32x32x16_bf16 v[40:55], v[168:171], v[136:139], 0
  global_load_dwordx4 v[160:163], v1, s[4:5] offset:-2048 sc1
  v_exp_f32 v24, v24
  v_exp_f32 v25, v25
  v_exp_f32 v26, v26
  v_exp_f32 v27, v27
  v_mfma_f32_32x32x16_bf16 v[40:55], v[172:175], v[140:143], v[40:55]
  global_load_dwordx4 v[164:167], v1, s[4:5] offset:-1024 sc1
  v_exp_f32 v28, v28
  v_exp_f32 v29, v29
  v_exp_f32 v30, v30
  v_exp_f32 v31, v31
  v_smfmac_f32_32x32x32_bf16 v[56:71], v[176:179], v[8:15], v2
  buffer_store_dword v234, v249, s[44:47], s58 offen sc1
  v_exp_f32 v32, v32
  v_cvt_pk_bf16_f32 v236, v224, v228
  v_exp_f32 v33, v33
  v_exp_f32 v34, v34
  v_exp_f32 v35, v35
  v_smfmac_f32_32x32x32_bf16 v[56:71], v[180:183], v[16:23], v2
  buffer_store_dword v235, v249, s[44:47], s59 offen sc1
  v_exp_f32 v36, v36
  v_cvt_pk_bf16_f32 v237, v225, v229
  v_exp_f32 v37, v37
  v_exp_f32 v38, v38
  v_exp_f32 v39, v39
  v_mfma_f32_32x32x16_bf16 v[8:23], v[168:171], v[144:147], 0
  buffer_store_dword v236, v249, s[44:47], s60 offen sc1
  v_exp_f32 v40, v40
  v_exp_f32 v41, v41
  v_exp_f32 v42, v42
  v_exp_f32 v43, v43
  v_mfma_f32_32x32x16_bf16 v[8:23], v[172:175], v[148:151], v[8:23]
  buffer_store_dword v237, v249, s[44:47], s61 offen sc1
  v_exp_f32 v44, v44
  v_exp_f32 v45, v45
  v_exp_f32 v46, v46
  v_exp_f32 v47, v47
  v_smfmac_f32_32x32x32_bf16 v[72:87], v[176:179], v[24:31], v2
  global_load_dwordx4 a[136:139], v1, s[6:7] offset:-2048 sc1
  v_exp_f32 v48, v48
  v_cvt_pk_bf16_f32 v238, v226, v230
  v_exp_f32 v49, v49
  v_exp_f32 v50, v50
  v_exp_f32 v51, v51
  v_smfmac_f32_32x32x32_bf16 v[72:87], v[180:183], v[32:39], v2
  s_waitcnt vmcnt(33)
  global_load_dwordx4 a[140:143], v1, s[6:7] offset:-1024 sc1
  v_exp_f32 v52, v52
  v_cvt_pk_bf16_f32 v239, v227, v231
  v_exp_f32 v53, v53
  v_exp_f32 v54, v54
  v_exp_f32 v55, v55
  v_mfma_f32_32x32x16_bf16 v[24:39], v[184:187], v[120:123], 0
  global_load_dwordx4 v[168:171], v1, s[4:5] offset:0 sc1
  v_exp_f32 v8, v8
  v_exp_f32 v9, v9
  v_exp_f32 v10, v10
  v_exp_f32 v11, v11
  v_mfma_f32_32x32x16_bf16 v[24:39], v[188:191], v[124:127], v[24:39]
  global_load_dwordx4 v[172:175], v1, s[4:5] offset:1024 sc1
  v_exp_f32 v12, v12
  v_exp_f32 v13, v13
  v_exp_f32 v14, v14
  v_exp_f32 v15, v15
  v_smfmac_f32_32x32x32_bf16 v[88:103], v[176:179], v[40:47], v2
  buffer_store_dword v238, v249, s[44:47], s62 offen sc1
  v_exp_f32 v16, v16
  v_exp_f32 v17, v17
  v_exp_f32 v18, v18
  v_exp_f32 v19, v19
  v_smfmac_f32_32x32x32_bf16 v[88:103], v[180:183], v[48:55], v2
  buffer_store_dword v239, v249, s[44:47], s63 offen sc1
  v_exp_f32 v20, v20
  v_exp_f32 v21, v21
  v_exp_f32 v22, v22
  v_exp_f32 v23, v23
  v_mfma_f32_32x32x16_bf16 v[40:55], v[184:187], v[128:131], 0
  global_load_dwordx4 a[144:147], v1, s[6:7] offset:0 sc1
  v_exp_f32 v24, v24
  v_exp_f32 v25, v25
  v_exp_f32 v26, v26
  v_exp_f32 v27, v27
  v_mfma_f32_32x32x16_bf16 v[40:55], v[188:191], v[132:135], v[40:55]
  global_load_dwordx4 a[148:151], v1, s[6:7] offset:1024 sc1
  v_exp_f32 v28, v28
  v_exp_f32 v29, v29
  v_exp_f32 v30, v30
  v_exp_f32 v31, v31
  v_smfmac_f32_32x32x32_bf16 v[104:119], v[176:179], v[8:15], v2
  global_load_dwordx4 a[152:155], v1, s[6:7] offset:2048 sc1
  v_exp_f32 v32, v32
  v_exp_f32 v33, v33
  v_exp_f32 v34, v34
  v_exp_f32 v35, v35
  v_smfmac_f32_32x32x32_bf16 v[104:119], v[180:183], v[16:23], v2
  s_waitcnt vmcnt(34)
  v_exp_f32 v36, v36
  v_exp_f32 v37, v37
  v_exp_f32 v38, v38
  v_exp_f32 v39, v39
  v_mfma_f32_32x32x16_bf16 v[8:23], v[184:187], v[136:139], 0
  global_load_dwordx4 v[176:179], v1, s[4:5] offset:2048 sc1
  v_exp_f32 v40, v40
  v_exp_f32 v41, v41
  v_exp_f32 v42, v42
  v_exp_f32 v43, v43
  v_mfma_f32_32x32x16_bf16 v[8:23], v[188:191], v[140:143], v[8:23]
  global_load_dwordx4 v[180:183], v1, s[4:5] offset:3072 sc1
  v_exp_f32 v44, v44
  v_exp_f32 v45, v45
  v_exp_f32 v46, v46
  v_exp_f32 v47, v47
  v_smfmac_f32_32x32x32_bf16 v[56:71], v[192:195], v[24:31], v2
  s_add_u32 s4, s4, 8192
  s_addc_u32 s5, s5, 0
  v_exp_f32 v48, v48
  v_exp_f32 v49, v49
  v_exp_f32 v50, v50
  v_exp_f32 v51, v51
  v_smfmac_f32_32x32x32_bf16 v[56:71], v[196:199], v[32:39], v2
  v_exp_f32 v52, v52
  v_exp_f32 v53, v53
  v_exp_f32 v54, v54
  v_exp_f32 v55, v55
  v_mfma_f32_32x32x16_bf16 v[24:39], v[184:187], v[144:147], 0
  global_load_dwordx4 a[156:159], v1, s[6:7] offset:3072 sc1
  v_exp_f32 v8, v8
  v_exp_f32 v9, v9
  v_exp_f32 v10, v10
  v_exp_f32 v11, v11
  v_mfma_f32_32x32x16_bf16 v[24:39], v[188:191], v[148:151], v[24:39]
  s_add_u32 s6, s6, 8192
  v_exp_f32 v12, v12
  v_exp_f32 v13, v13
  v_exp_f32 v14, v14
  v_exp_f32 v15, v15
  v_smfmac_f32_32x32x32_bf16 v[72:87], v[192:195], v[40:47], v2
  s_addc_u32 s7, s7, 0
  global_load_dwordx4 a[160:163], v1, s[6:7] offset:-4096 sc1
  v_exp_f32 v16, v16
  v_exp_f32 v17, v17
  v_exp_f32 v18, v18
  v_exp_f32 v19, v19
  v_smfmac_f32_32x32x32_bf16 v[72:87], v[196:199], v[48:55], v2
  s_waitcnt vmcnt(33)
  global_load_dwordx4 a[164:167], v1, s[6:7] offset:-3072 sc1
  v_exp_f32 v20, v20
  v_exp_f32 v21, v21
  v_exp_f32 v22, v22
  v_exp_f32 v23, v23
  v_mfma_f32_32x32x16_bf16 v[40:55], v[200:203], v[120:123], 0
  global_load_dwordx4 v[184:187], v1, s[4:5] offset:-4096 sc1
  v_exp_f32 v24, v24
  v_exp_f32 v25, v25
  v_exp_f32 v26, v26
  v_exp_f32 v27, v27
  v_mfma_f32_32x32x16_bf16 v[40:55], v[204:207], v[124:127], v[40:55]
  global_load_dwordx4 v[188:191], v1, s[4:5] offset:-3072 sc1
  v_exp_f32 v28, v28
  v_exp_f32 v29, v29
  v_exp_f32 v30, v30
  v_exp_f32 v31, v31
  v_smfmac_f32_32x32x32_bf16 v[88:103], v[192:195], v[8:15], v2
  v_exp_f32 v32, v32
  v_exp_f32 v33, v33
  v_exp_f32 v34, v34
  v_exp_f32 v35, v35
  v_smfmac_f32_32x32x32_bf16 v[88:103], v[196:199], v[16:23], v2
  v_exp_f32 v36, v36
  v_exp_f32 v37, v37
  v_exp_f32 v38, v38
  v_exp_f32 v39, v39
  v_mfma_f32_32x32x16_bf16 v[8:23], v[200:203], v[128:131], 0
  global_load_dwordx4 a[168:171], v1, s[6:7] offset:-2048 sc1
  v_exp_f32 v40, v40
  v_exp_f32 v41, v41
  v_exp_f32 v42, v42
  v_exp_f32 v43, v43
  v_mfma_f32_32x32x16_bf16 v[8:23], v[204:207], v[132:135], v[8:23]
  global_load_dwordx4 a[172:175], v1, s[6:7] offset:-1024 sc1
  v_exp_f32 v44, v44
  v_exp_f32 v45, v45
  v_exp_f32 v46, v46
  v_exp_f32 v47, v47
  v_smfmac_f32_32x32x32_bf16 v[104:119], v[192:195], v[24:31], v2
  global_load_dwordx4 a[176:179], v1, s[6:7] offset:0 sc1
  v_exp_f32 v48, v48
  v_exp_f32 v49, v49
  v_exp_f32 v50, v50
  v_exp_f32 v51, v51
  v_smfmac_f32_32x32x32_bf16 v[104:119], v[196:199], v[32:39], v2
  s_waitcnt vmcnt(34)
  v_exp_f32 v52, v52
  v_exp_f32 v53, v53
  v_exp_f32 v54, v54
  v_exp_f32 v55, v55
  v_mfma_f32_32x32x16_bf16 v[24:39], v[200:203], v[136:139], 0
  global_load_dwordx4 v[192:195], v1, s[4:5] offset:-2048 sc1
  v_exp_f32 v8, v8
  v_exp_f32 v9, v9
  v_exp_f32 v10, v10
  v_exp_f32 v11, v11
  v_mfma_f32_32x32x16_bf16 v[24:39], v[204:207], v[140:143], v[24:39]
  global_load_dwordx4 v[196:199], v1, s[4:5] offset:-1024 sc1
  v_exp_f32 v12, v12
  v_exp_f32 v13, v13
  v_exp_f32 v14, v14
  v_exp_f32 v15, v15
  v_smfmac_f32_32x32x32_bf16 v[56:71], v[208:211], v[40:47], v2
  v_exp_f32 v16, v16
  v_exp_f32 v17, v17
  v_exp_f32 v18, v18
  v_exp_f32 v19, v19
  v_smfmac_f32_32x32x32_bf16 v[56:71], v[212:215], v[48:55], v2
  v_exp_f32 v20, v20
  v_exp_f32 v21, v21
  v_exp_f32 v22, v22
  v_exp_f32 v23, v23
  v_mfma_f32_32x32x16_bf16 v[40:55], v[200:203], v[144:147], 0
  global_load_dwordx4 a[180:183], v1, s[6:7] offset:1024 sc1
  v_exp_f32 v24, v24
  v_exp_f32 v25, v25
  v_exp_f32 v26, v26
  v_exp_f32 v27, v27
  v_mfma_f32_32x32x16_bf16 v[40:55], v[204:207], v[148:151], v[40:55]
  global_load_dwordx4 a[184:187], v1, s[6:7] offset:2048 sc1
  v_exp_f32 v28, v28
  v_exp_f32 v29, v29
  v_exp_f32 v30, v30
  v_exp_f32 v31, v31
  v_smfmac_f32_32x32x32_bf16 v[72:87], v[208:211], v[8:15], v2
  global_load_dwordx4 a[188:191], v1, s[6:7] offset:3072 sc1
  v_exp_f32 v32, v32
  v_exp_f32 v33, v33
  v_exp_f32 v34, v34
  v_exp_f32 v35, v35
  v_smfmac_f32_32x32x32_bf16 v[72:87], v[212:215], v[16:23], v2
  s_waitcnt vmcnt(34)
  s_add_u32 s6, s6, 8192
  v_exp_f32 v36, v36
  v_exp_f32 v37, v37
  v_exp_f32 v38, v38
  v_exp_f32 v39, v39
  v_mfma_f32_32x32x16_bf16 v[8:23], v[152:155], v[120:123], 0
  global_load_dwordx4 v[200:203], v1, s[4:5] offset:0 sc1
  v_exp_f32 v40, v40
  v_exp_f32 v41, v41
  v_exp_f32 v42, v42
  v_exp_f32 v43, v43
  v_mfma_f32_32x32x16_bf16 v[8:23], v[156:159], v[124:127], v[8:23]
  global_load_dwordx4 v[204:207], v1, s[4:5] offset:1024 sc1
  v_exp_f32 v44, v44
  v_exp_f32 v45, v45
  v_exp_f32 v46, v46
  v_exp_f32 v47, v47
  v_smfmac_f32_32x32x32_bf16 v[88:103], v[208:211], v[24:31], v2
  s_addc_u32 s7, s7, 0
  v_exp_f32 v48, v48
  v_exp_f32 v49, v49
  v_exp_f32 v50, v50
  v_exp_f32 v51, v51
  v_smfmac_f32_32x32x32_bf16 v[88:103], v[212:215], v[32:39], v2
  v_exp_f32 v52, v52
  v_exp_f32 v53, v53
  v_exp_f32 v54, v54
  v_exp_f32 v55, v55
  v_mfma_f32_32x32x16_bf16 v[24:39], v[152:155], v[128:131], 0
  global_load_dwordx4 a[192:195], v1, s[6:7] offset:-4096 sc1
  v_exp_f32 v8, v8
  v_exp_f32 v9, v9
  v_exp_f32 v10, v10
  v_exp_f32 v11, v11
  v_mfma_f32_32x32x16_bf16 v[24:39], v[156:159], v[132:135], v[24:39]
  global_load_dwordx4 a[196:199], v1, s[6:7] offset:-3072 sc1
  v_exp_f32 v12, v12
  v_exp_f32 v13, v13
  v_exp_f32 v14, v14
  v_exp_f32 v15, v15
  v_smfmac_f32_32x32x32_bf16 v[104:119], v[208:211], v[40:47], v2
  global_load_dwordx4 a[200:203], v1, s[6:7] offset:-2048 sc1
  v_exp_f32 v16, v16
  v_exp_f32 v17, v17
  v_exp_f32 v18, v18
  v_exp_f32 v19, v19
  v_smfmac_f32_32x32x32_bf16 v[104:119], v[212:215], v[48:55], v2
  s_waitcnt vmcnt(33)
  v_exp_f32 v20, v20
  v_exp_f32 v21, v21
  v_exp_f32 v22, v22
  v_exp_f32 v23, v23
  v_mfma_f32_32x32x16_bf16 v[40:55], v[152:155], v[136:139], 0
  global_load_dwordx4 v[208:211], v1, s[4:5] offset:2048 sc1
  v_exp_f32 v24, v24
  v_exp_f32 v25, v25
  v_exp_f32 v26, v26
  v_exp_f32 v27, v27
  v_mfma_f32_32x32x16_bf16 v[40:55], v[156:159], v[140:143], v[40:55]
  global_load_dwordx4 v[212:215], v1, s[4:5] offset:3072 sc1
  v_exp_f32 v28, v28
  v_exp_f32 v29, v29
  v_exp_f32 v30, v30
  v_exp_f32 v31, v31
  v_smfmac_f32_32x32x32_bf16 v[56:71], v[160:163], v[8:15], v2
  s_add_u32 s4, s4, 8192
  s_addc_u32 s5, s5, 0
  v_exp_f32 v32, v32
  v_exp_f32 v33, v33
  v_exp_f32 v34, v34
  v_exp_f32 v35, v35
  v_smfmac_f32_32x32x32_bf16 v[56:71], v[164:167], v[16:23], v2
  v_exp_f32 v36, v36
  v_exp_f32 v37, v37
  v_exp_f32 v38, v38
  v_exp_f32 v39, v39
  v_mfma_f32_32x32x16_bf16 v[8:23], v[152:155], v[144:147], 0
  global_load_dwordx4 a[204:207], v1, s[6:7] offset:-1024 sc1
  v_exp_f32 v40, v40
  v_exp_f32 v41, v41
  v_exp_f32 v42, v42
  v_exp_f32 v43, v43
  v_mfma_f32_32x32x16_bf16 v[8:23], v[156:159], v[148:151], v[8:23]
  global_load_dwordx4 a[208:211], v1, s[6:7] offset:0 sc1
  v_exp_f32 v44, v44
  v_exp_f32 v45, v45
  v_exp_f32 v46, v46
  v_exp_f32 v47, v47
  v_smfmac_f32_32x32x32_bf16 v[72:87], v[160:163], v[24:31], v2
  global_load_dwordx4 a[212:215], v1, s[6:7] offset:1024 sc1
  v_exp_f32 v48, v48
  v_exp_f32 v49, v49
  v_exp_f32 v50, v50
  v_exp_f32 v51, v51
  v_smfmac_f32_32x32x32_bf16 v[72:87], v[164:167], v[32:39], v2
  s_waitcnt vmcnt(30)
  v_exp_f32 v52, v52
  v_exp_f32 v53, v53
  v_exp_f32 v54, v54
  v_exp_f32 v55, v55
  v_mfma_f32_32x32x16_bf16 v[24:39], v[168:171], v[120:123], 0
  global_load_dwordx4 a[216:219], v1, s[6:7] offset:2048 sc1
  v_exp_f32 v8, v8
  v_exp_f32 v9, v9
  v_exp_f32 v10, v10
  v_exp_f32 v11, v11
  v_mfma_f32_32x32x16_bf16 v[24:39], v[172:175], v[124:127], v[24:39]
  global_load_dwordx4 a[220:223], v1, s[6:7] offset:3072 sc1
  v_exp_f32 v12, v12
  v_exp_f32 v13, v13
  v_exp_f32 v14, v14
  v_exp_f32 v15, v15
  v_smfmac_f32_32x32x32_bf16 v[88:103], v[160:163], v[40:47], v2
  s_add_u32 s6, s6, 8192
  s_addc_u32 s7, s7, 0
  v_exp_f32 v16, v16
  v_exp_f32 v17, v17
  v_exp_f32 v18, v18
  v_exp_f32 v19, v19
  v_smfmac_f32_32x32x32_bf16 v[88:103], v[164:167], v[48:55], v2
  s_waitcnt vmcnt(20)
  v_exp_f32 v20, v20
  v_exp_f32 v21, v21
  v_exp_f32 v22, v22
  v_exp_f32 v23, v23
  v_mfma_f32_32x32x16_bf16 v[40:55], v[184:187], v[120:123], 0
  global_load_dwordx4 a[224:227], v1, s[6:7] offset:-4096 sc1
  v_exp_f32 v24, v24
  v_exp_f32 v25, v25
  v_exp_f32 v26, v26
  v_exp_f32 v27, v27
  v_mfma_f32_32x32x16_bf16 v[40:55], v[188:191], v[124:127], v[40:55]
  global_load_dwordx4 a[228:231], v1, s[6:7] offset:-3072 sc1
  v_exp_f32 v28, v28
  v_exp_f32 v29, v29
  v_exp_f32 v30, v30
  v_exp_f32 v31, v31
  v_smfmac_f32_32x32x32_bf16 v[104:119], v[160:163], v[8:15], v2
  global_load_dwordx4 a[232:235], v1, s[6:7] offset:-2048 sc1
  v_exp_f32 v32, v32
  v_exp_f32 v33, v33
  v_exp_f32 v34, v34
  v_exp_f32 v35, v35
  v_smfmac_f32_32x32x32_bf16 v[104:119], v[164:167], v[16:23], v2
  s_waitcnt vmcnt(13)
  v_exp_f32 v36, v36
  v_exp_f32 v37, v37
  v_exp_f32 v38, v38
  v_exp_f32 v39, v39
  v_mfma_f32_32x32x16_bf16 v[8:23], v[200:203], v[120:123], 0
  global_load_dwordx4 a[236:239], v1, s[6:7] offset:-1024 sc1
  v_exp_f32 v40, v40
  v_exp_f32 v41, v41
  v_exp_f32 v42, v42
  v_exp_f32 v43, v43
  v_mfma_f32_32x32x16_bf16 v[8:23], v[204:207], v[124:127], v[8:23]
  global_load_dwordx4 a[240:243], v1, s[6:7] offset:0 sc1
  v_exp_f32 v44, v44
  v_exp_f32 v45, v45
  v_exp_f32 v46, v46
  v_exp_f32 v47, v47
  v_smfmac_f32_32x32x32_bf16 v[56:71], v[176:179], v[24:31], v2
  v_exp_f32 v48, v48
  v_exp_f32 v49, v49
  v_exp_f32 v50, v50
  v_exp_f32 v51, v51
  v_smfmac_f32_32x32x32_bf16 v[56:71], v[180:183], v[32:39], v2
  v_exp_f32 v52, v52
  v_exp_f32 v53, v53
  v_exp_f32 v54, v54
  v_exp_f32 v55, v55
  v_mfma_f32_32x32x16_bf16 v[24:39], v[168:171], v[128:131], 0
  global_load_dwordx4 a[244:247], v1, s[6:7] offset:1024 sc1
  v_exp_f32 v8, v8
  v_exp_f32 v9, v9
  v_exp_f32 v10, v10
  v_exp_f32 v11, v11
  v_mfma_f32_32x32x16_bf16 v[24:39], v[172:175], v[132:135], v[24:39]
  global_load_dwordx4 a[248:251], v1, s[6:7] offset:2048 sc1
  v_exp_f32 v12, v12
  v_exp_f32 v13, v13
  v_exp_f32 v14, v14
  v_exp_f32 v15, v15
  v_smfmac_f32_32x32x32_bf16 v[56:71], v[192:195], v[40:47], v2
  s_waitcnt vmcnt(12)
  global_load_dwordx4 a[252:255], v1, s[6:7] offset:3072 sc1
  v_exp_f32 v16, v16
  v_exp_f32 v17, v17
  v_exp_f32 v18, v18
  v_exp_f32 v19, v19
  v_smfmac_f32_32x32x32_bf16 v[56:71], v[196:199], v[48:55], v2
  s_add_u32 s6, s6, 8192
  s_addc_u32 s7, s7, 0
  v_exp_f32 v20, v20
  v_exp_f32 v21, v21
  v_exp_f32 v22, v22
  v_exp_f32 v23, v23
  v_mfma_f32_32x32x16_bf16 v[40:55], v[184:187], v[128:131], 0
  global_load_dwordx4 v[216:219], v1, s[6:7] offset:-4096 sc1
  v_exp_f32 v24, v24
  v_exp_f32 v25, v25
  v_exp_f32 v26, v26
  v_exp_f32 v27, v27
  v_mfma_f32_32x32x16_bf16 v[40:55], v[188:191], v[132:135], v[40:55]
  global_load_dwordx4 v[220:223], v1, s[6:7] offset:-3072 sc1
  v_exp_f32 v28, v28
  v_exp_f32 v29, v29
  v_exp_f32 v30, v30
  v_exp_f32 v31, v31
  v_smfmac_f32_32x32x32_bf16 v[56:71], v[208:211], v[8:15], v2
  v_exp_f32 v32, v32
  v_exp_f32 v33, v33
  v_exp_f32 v34, v34
  v_exp_f32 v35, v35
  v_smfmac_f32_32x32x32_bf16 v[56:71], v[212:215], v[16:23], v2
  v_exp_f32 v36, v36
  v_exp_f32 v37, v37
  v_exp_f32 v38, v38
  v_exp_f32 v39, v39
  v_mfma_f32_32x32x16_bf16 v[8:23], v[200:203], v[128:131], 0
  global_load_dwordx4 v[224:227], v1, s[6:7] offset:-2048 sc1
  v_exp_f32 v40, v40
  v_exp_f32 v41, v41
  v_exp_f32 v42, v42
  v_exp_f32 v43, v43
  v_mfma_f32_32x32x16_bf16 v[8:23], v[204:207], v[132:135], v[8:23]
  global_load_dwordx4 v[228:231], v1, s[6:7] offset:-1024 sc1
  v_exp_f32 v44, v44
  v_exp_f32 v45, v45
  v_exp_f32 v46, v46
  v_exp_f32 v47, v47
  v_smfmac_f32_32x32x32_bf16 v[72:87], v[176:179], v[24:31], v2
  ds_write_b128 v4, v[56:59] offset:0
  v_exp_f32 v48, v48
  v_exp_f32 v49, v49
  v_exp_f32 v50, v50
  v_exp_f32 v51, v51
  v_smfmac_f32_32x32x32_bf16 v[72:87], v[180:183], v[32:39], v2
  ds_write_b128 v4, v[60:63] offset:1024
  v_exp_f32 v52, v52
  v_exp_f32 v53, v53
  v_exp_f32 v54, v54
  v_exp_f32 v55, v55
  v_mfma_f32_32x32x16_bf16 v[24:39], v[168:171], v[136:139], 0
  ds_write_b128 v4, v[64:67] offset:2048
  v_exp_f32 v8, v8
  v_exp_f32 v9, v9
  v_exp_f32 v10, v10
  v_exp_f32 v11, v11
  v_mfma_f32_32x32x16_bf16 v[24:39], v[172:175], v[140:143], v[24:39]
  ds_write_b128 v4, v[68:71] offset:3072
  v_exp_f32 v12, v12
  v_exp_f32 v13, v13
  v_exp_f32 v14, v14
  v_exp_f32 v15, v15
  v_smfmac_f32_32x32x32_bf16 v[72:87], v[192:195], v[40:47], v2
  global_load_dwordx4 v[232:235], v1, s[6:7] offset:0 sc1
  v_exp_f32 v16, v16
  v_exp_f32 v17, v17
  v_exp_f32 v18, v18
  v_exp_f32 v19, v19
  v_smfmac_f32_32x32x32_bf16 v[72:87], v[196:199], v[48:55], v2
  global_load_dwordx4 v[236:239], v1, s[6:7] offset:1024 sc1
  v_exp_f32 v20, v20
  v_exp_f32 v21, v21
  v_exp_f32 v22, v22
  v_exp_f32 v23, v23
  v_mfma_f32_32x32x16_bf16 v[40:55], v[184:187], v[136:139], 0
  global_load_dwordx4 v[240:243], v1, s[6:7] offset:2048 sc1
  v_exp_f32 v24, v24
  v_exp_f32 v25, v25
  v_exp_f32 v26, v26
  v_exp_f32 v27, v27
  v_mfma_f32_32x32x16_bf16 v[40:55], v[188:191], v[140:143], v[40:55]
  global_load_dwordx4 v[244:247], v1, s[6:7] offset:3072 sc1
  v_exp_f32 v28, v28
  v_exp_f32 v29, v29
  v_exp_f32 v30, v30
  v_exp_f32 v31, v31
  v_smfmac_f32_32x32x32_bf16 v[72:87], v[208:211], v[8:15], v2
  s_add_u32 s6, s6, 8192
  s_addc_u32 s7, s7, 0
  v_exp_f32 v32, v32
  v_exp_f32 v33, v33
  v_exp_f32 v34, v34
  v_exp_f32 v35, v35
  v_smfmac_f32_32x32x32_bf16 v[72:87], v[212:215], v[16:23], v2
  global_load_dwordx4 v[248:251], v1, s[6:7] offset:-4096 sc1
  v_exp_f32 v36, v36
  v_exp_f32 v37, v37
  v_exp_f32 v38, v38
  v_exp_f32 v39, v39
  v_mfma_f32_32x32x16_bf16 v[8:23], v[200:203], v[136:139], 0
  global_load_dwordx4 v[252:255], v1, s[6:7] offset:-3072 sc1
  v_exp_f32 v40, v40
  v_exp_f32 v41, v41
  v_exp_f32 v42, v42
  v_exp_f32 v43, v43
  v_mfma_f32_32x32x16_bf16 v[8:23], v[204:207], v[140:143], v[8:23]
  global_load_dwordx4 v[152:155], v1, s[6:7] offset:-2048 sc1
  v_exp_f32 v44, v44
  v_exp_f32 v45, v45
  v_exp_f32 v46, v46
  v_exp_f32 v47, v47
  v_smfmac_f32_32x32x32_bf16 v[88:103], v[176:179], v[24:31], v2
  ds_write_b128 v4, v[72:75] offset:4096
  v_exp_f32 v48, v48
  v_exp_f32 v49, v49
  v_exp_f32 v50, v50
  v_exp_f32 v51, v51
  v_smfmac_f32_32x32x32_bf16 v[88:103], v[180:183], v[32:39], v2
  ds_write_b128 v4, v[76:79] offset:5120
  v_exp_f32 v52, v52
  v_exp_f32 v53, v53
  v_exp_f32 v54, v54
  v_exp_f32 v55, v55
  v_mfma_f32_32x32x16_bf16 v[24:39], v[168:171], v[144:147], 0
  ds_write_b128 v4, v[80:83] offset:6144
  v_exp_f32 v8, v8
  v_exp_f32 v9, v9
  v_exp_f32 v10, v10
  v_exp_f32 v11, v11
  v_mfma_f32_32x32x16_bf16 v[24:39], v[172:175], v[148:151], v[24:39]
  ds_write_b128 v4, v[84:87] offset:7168
  v_exp_f32 v12, v12
  v_exp_f32 v13, v13
  v_exp_f32 v14, v14
  v_exp_f32 v15, v15
  v_smfmac_f32_32x32x32_bf16 v[88:103], v[192:195], v[40:47], v2
  global_load_dwordx4 v[156:159], v1, s[6:7] offset:-1024 sc1
  v_exp_f32 v16, v16
  v_exp_f32 v17, v17
  v_exp_f32 v18, v18
  v_exp_f32 v19, v19
  v_smfmac_f32_32x32x32_bf16 v[88:103], v[196:199], v[48:55], v2
  global_load_dwordx4 v[160:163], v1, s[6:7] offset:0 sc1
  v_exp_f32 v20, v20
  v_exp_f32 v21, v21
  v_exp_f32 v22, v22
  v_exp_f32 v23, v23
  v_mfma_f32_32x32x16_bf16 v[40:55], v[184:187], v[144:147], 0
  global_load_dwordx4 v[164:167], v1, s[6:7] offset:1024 sc1
  v_exp_f32 v24, v24
  v_exp_f32 v25, v25
  v_exp_f32 v26, v26
  v_exp_f32 v27, v27
  v_mfma_f32_32x32x16_bf16 v[40:55], v[188:191], v[148:151], v[40:55]
  global_load_dwordx4 v[120:123], v1, s[6:7] offset:2048 sc1
  v_exp_f32 v28, v28
  v_exp_f32 v29, v29
  v_exp_f32 v30, v30
  v_exp_f32 v31, v31
  v_smfmac_f32_32x32x32_bf16 v[88:103], v[208:211], v[8:15], v2
  global_load_dwordx4 v[124:127], v1, s[6:7] offset:3072 sc1
  v_exp_f32 v32, v32
  v_exp_f32 v33, v33
  v_exp_f32 v34, v34
  v_exp_f32 v35, v35
  v_smfmac_f32_32x32x32_bf16 v[88:103], v[212:215], v[16:23], v2
  s_add_u32 s6, s6, 8192
  s_addc_u32 s7, s7, 0
  v_exp_f32 v36, v36
  v_exp_f32 v37, v37
  v_exp_f32 v38, v38
  v_exp_f32 v39, v39
  v_mfma_f32_32x32x16_bf16 v[8:23], v[200:203], v[144:147], 0
  global_load_dwordx4 v[128:131], v1, s[6:7] offset:-4096 sc1
  v_exp_f32 v40, v40
  v_exp_f32 v41, v41
  v_exp_f32 v42, v42
  v_exp_f32 v43, v43
  v_mfma_f32_32x32x16_bf16 v[8:23], v[204:207], v[148:151], v[8:23]
  global_load_dwordx4 v[132:135], v1, s[6:7] offset:-3072 sc1
  v_exp_f32 v44, v44
  v_exp_f32 v45, v45
  v_exp_f32 v46, v46
  v_exp_f32 v47, v47
  v_smfmac_f32_32x32x32_bf16 v[104:119], v[176:179], v[24:31], v2
  ds_write_b128 v4, v[88:91] offset:8192
  ds_write_b128 v4, v[92:95] offset:9216
  v_exp_f32 v48, v48
  v_exp_f32 v49, v49
  v_exp_f32 v50, v50
  v_exp_f32 v51, v51
  v_smfmac_f32_32x32x32_bf16 v[104:119], v[180:183], v[32:39], v2
  ds_write_b128 v4, v[96:99] offset:10240
  ds_write_b128 v4, v[100:103] offset:11264
  v_exp_f32 v52, v52
  v_exp_f32 v53, v53
  v_exp_f32 v54, v54
  v_exp_f32 v55, v55
  v_smfmac_f32_32x32x32_bf16 v[104:119], v[192:195], v[40:47], v2
  global_load_dwordx4 v[136:139], v1, s[6:7] offset:-2048 sc1
  v_exp_f32 v8, v8
  v_exp_f32 v9, v9
  v_exp_f32 v10, v10
  v_exp_f32 v11, v11
  v_smfmac_f32_32x32x32_bf16 v[104:119], v[196:199], v[48:55], v2
  s_waitcnt lgkmcnt(0)
  s_barrier
  ds_read_b128 v[68:71], v5 offset:3072
  ds_read_b128 v[56:59], v5 offset:0
  ds_read_b128 v[60:63], v5 offset:1024
  ds_read_b128 v[64:67], v5 offset:2048
  v_exp_f32 v12, v12
  v_exp_f32 v13, v13
  v_exp_f32 v14, v14
  v_exp_f32 v15, v15
  ds_read_b128 v[84:87], v6 offset:7168
  ds_read_b128 v[72:75], v6 offset:4096
  ds_read_b128 v[76:79], v6 offset:5120
  ds_read_b128 v[80:83], v6 offset:6144
  v_exp_f32 v16, v16
  v_exp_f32 v17, v17
  v_exp_f32 v18, v18
  v_exp_f32 v19, v19
  v_smfmac_f32_32x32x32_bf16 v[104:119], v[208:211], v[8:15], v2
  ds_read_b128 v[100:103], v7 offset:11264
  ds_read_b128 v[88:91], v7 offset:8192
  ds_read_b128 v[92:95], v7 offset:9216
  ds_read_b128 v[96:99], v7 offset:10240
  v_exp_f32 v20, v20
  v_exp_f32 v21, v21
  v_exp_f32 v22, v22
  v_exp_f32 v23, v23
  v_and_b32 v24, 7, v0
  v_bfe_u32 v25, v0, 1, 2
  v_smfmac_f32_32x32x32_bf16 v[104:119], v[212:215], v[16:23], v2
  global_load_dwordx4 v[140:143], v1, s[6:7] offset:-1024 sc1
  v_mul_u32_u24 v24, 896, v24
  v_lshl_add_u32 v24, v25, 5, v24
  v_bfe_u32 v25, v0, 3, 2
  v_mad_u32_u24 v24, v25, 56, v24
  v_lshrrev_b32 v25, 5, v0
  v_lshl_add_u32 v24, v25, 3, v24
  s_mul_i32 s65, s3, 224
  s_add_u32 s39, s65, 49152
  v_add_u32 v24, s39, v24
  s_waitcnt lgkmcnt(7)
  v_pk_add_f32 v[68:69], v[68:69], v[84:85]
  v_pk_add_f32 v[70:71], v[70:71], v[86:87]
  s_waitcnt lgkmcnt(6)
  v_pk_add_f32 v[56:57], v[56:57], v[72:73]
  v_pk_add_f32 v[58:59], v[58:59], v[74:75]
  s_waitcnt lgkmcnt(5)
  v_pk_add_f32 v[60:61], v[60:61], v[76:77]
  v_pk_add_f32 v[62:63], v[62:63], v[78:79]
  s_waitcnt lgkmcnt(4)
  v_pk_add_f32 v[64:65], v[64:65], v[80:81]
  v_pk_add_f32 v[66:67], v[66:67], v[82:83]
  s_waitcnt lgkmcnt(3)
  v_pk_add_f32 v[68:69], v[68:69], v[100:101]
  v_pk_add_f32 v[70:71], v[70:71], v[102:103]
  s_waitcnt lgkmcnt(2)
  v_pk_add_f32 v[56:57], v[56:57], v[88:89]
  v_pk_add_f32 v[58:59], v[58:59], v[90:91]
  s_waitcnt lgkmcnt(1)
  v_pk_add_f32 v[60:61], v[60:61], v[92:93]
  v_pk_add_f32 v[62:63], v[62:63], v[94:95]
  s_waitcnt lgkmcnt(0)
  v_pk_add_f32 v[64:65], v[64:65], v[96:97]
  v_pk_add_f32 v[66:67], v[66:67], v[98:99]
  v_pk_add_f32 v[116:117], v[68:69], v[116:117]
  v_pk_add_f32 v[118:119], v[70:71], v[118:119]
  v_mov_b32 v30, v116
  v_mov_b32 v31, v116
  v_pk_add_f32 v[104:105], v[56:57], v[104:105]
  v_pk_add_f32 v[106:107], v[58:59], v[106:107]
  v_permlane32_swap_b32 v31, v30
  v_pk_add_f32 v[108:109], v[60:61], v[108:109]
  v_pk_add_f32 v[110:111], v[62:63], v[110:111]
  v_rcp_f32 v32, v30
  v_pk_add_f32 v[112:113], v[64:65], v[112:113]
  v_pk_add_f32 v[114:115], v[66:67], v[114:115]
  v_pk_mul_f32 v[88:89], v[104:105], v[32:33] op_sel_hi:[1,0]
  v_pk_mul_f32 v[90:91], v[106:107], v[32:33] op_sel_hi:[1,0]
  v_cvt_pk_bf16_f32 v88, v88, v89
  v_cvt_pk_bf16_f32 v89, v90, v91
  ds_write_b64 v24, v[88:89] offset:0
  v_pk_mul_f32 v[92:93], v[108:109], v[32:33] op_sel_hi:[1,0]
  v_pk_mul_f32 v[94:95], v[110:111], v[32:33] op_sel_hi:[1,0]
  v_cvt_pk_bf16_f32 v92, v92, v93
  v_cvt_pk_bf16_f32 v93, v94, v95
  ds_write_b64 v24, v[92:93] offset:16
  v_pk_mul_f32 v[96:97], v[112:113], v[32:33] op_sel_hi:[1,0]
  v_pk_mul_f32 v[98:99], v[114:115], v[32:33] op_sel_hi:[1,0]
  v_cvt_pk_bf16_f32 v96, v96, v97
  v_cvt_pk_bf16_f32 v97, v98, v99
  ds_write_b64 v24, v[96:97] offset:32
  v_pk_mul_f32 v[100:101], v[116:117], v[32:33] op_sel_hi:[1,0]
  v_pk_mul_f32 v[102:103], v[118:119], v[32:33] op_sel_hi:[1,0]
  v_cvt_pk_bf16_f32 v100, v100, v101
  v_cvt_pk_bf16_f32 v101, v102, v103
  s_mov_b32 exec_hi, 0
  ds_write_b64 v24, v[100:101] offset:48
  s_mov_b32 exec_hi, -1
  global_load_dwordx4 v[168:171], v1, s[6:7] offset:0 sc1
  global_load_dwordx4 v[172:175], v1, s[6:7] offset:1024 sc1
  global_load_dwordx4 v[184:187], v1, s[6:7] offset:2048 sc1
  v_bfe_u32 v26, v0, 1, 3
  v_mul_u32_u24 v26, 896, v26
  v_bfe_u32 v27, v0, 2, 2
  v_lshl_add_u32 v26, v27, 5, v26
  v_lshrrev_b32 v29, 4, v0
  v_lshl_add_u32 v26, v29, 4, v26
  v_and_b32 v27, 1, v0
  v_lshl_add_u32 v26, v27, 6, v26
  s_waitcnt lgkmcnt(0)
  s_barrier
  ds_read_b128 v[40:43], v26 offset:49152
  ds_read_b128 v[44:47], v26 offset:49280
  ds_read_b128 v[48:51], v26 offset:49408
  ds_read_b128 v[52:55], v26 offset:49536
  ds_read_b128 v[8:11], v26 offset:49664
  ds_read_b128 v[12:15], v26 offset:49792
  ds_read_b128 v[16:19], v26 offset:49920
  global_load_dwordx4 v[188:191], v1, s[6:7] offset:3072 sc1
  s_add_u32 s6, s6, 8192
  s_addc_u32 s7, s7, 0
  global_load_dwordx4 v[176:179], v1, s[6:7] offset:-4096 sc1
  v_mul_u32_u24 v27, 0x5555, v27
  v_add_u32 v27, 0x8888, v27
  v_mov_b64 v[56:57], 0
  v_mov_b64 v[58:59], 0
  v_mov_b64 v[60:61], 0
  v_mov_b64 v[62:63], 0
  v_mov_b64 v[64:65], 0
  v_mov_b64 v[66:67], 0
  v_mov_b64 v[68:69], 0
  v_mov_b64 v[70:71], 0
  v_mov_b64 v[72:73], 0
  v_mov_b64 v[74:75], 0
  v_mov_b64 v[76:77], 0
  v_mov_b64 v[78:79], 0
  v_mov_b64 v[80:81], 0
  v_mov_b64 v[82:83], 0
  s_waitcnt lgkmcnt(6)
  v_smfmac_f32_16x16x64_bf16 v[56:59], v[40:43], a[0:7], v27
  v_mul_u32_u24 v28, 3584, v29
  v_smfmac_f32_16x16x64_bf16 v[60:63], v[40:43], a[56:63], v27
  global_load_dwordx4 v[180:183], v1, s[6:7] offset:-3072 sc1
  v_smfmac_f32_16x16x64_bf16 v[64:67], v[40:43], a[112:119], v27
  v_and_b32 v29, 15, v0
  s_waitcnt lgkmcnt(5)
  v_smfmac_f32_16x16x64_bf16 v[56:59], v[44:47], a[8:15], v27
  global_load_dwordx4 v[200:203], v1, s[6:7] offset:-2048 sc1
  v_smfmac_f32_16x16x64_bf16 v[60:63], v[44:47], a[64:71], v27
  v_lshl_add_u32 v33, v29, 1, v28
  v_smfmac_f32_16x16x64_bf16 v[64:67], v[44:47], a[120:127], v27
  global_load_dwordx4 v[204:207], v1, s[6:7] offset:-1024 sc1
  s_waitcnt lgkmcnt(4)
  v_smfmac_f32_16x16x64_bf16 v[56:59], v[48:51], a[16:23], v27
  v_mad_u32_u24 v28, v29, 12, v28
  s_mul_i32 s66, s26, 14336
  s_add_u32 s66, s66, s65
  v_smfmac_f32_16x16x64_bf16 v[60:63], v[48:51], a[72:79], v27
  global_load_dwordx4 v[144:147], v1, s[6:7] offset:0 sc1
  v_smfmac_f32_16x16x64_bf16 v[64:67], v[48:51], a[128:135], v27
  v_add_f32 v31, |v104|, |v105|
  s_waitcnt lgkmcnt(3)
  v_smfmac_f32_16x16x64_bf16 v[56:59], v[52:55], a[24:31], v27
  global_load_dwordx4 v[148:151], v1, s[6:7] offset:1024 sc1
  v_smfmac_f32_16x16x64_bf16 v[60:63], v[52:55], a[80:87], v27
  v_add_f32 v31, v31, |v106|
  v_smfmac_f32_16x16x64_bf16 v[64:67], v[52:55], a[136:143], v27
  global_load_dwordx4 v[192:195], v1, s[6:7] offset:2048 sc1
  s_waitcnt lgkmcnt(2)
  v_smfmac_f32_16x16x64_bf16 v[56:59], v[8:11], a[32:39], v27
  v_add_f32 v31, v31, |v107|
  v_smfmac_f32_16x16x64_bf16 v[60:63], v[8:11], a[88:95], v27
  global_load_dwordx4 v[196:199], v1, s[6:7] offset:3072 sc1
  v_smfmac_f32_16x16x64_bf16 v[64:67], v[8:11], a[144:151], v27
  v_add_f32 v31, v31, |v108|
  s_waitcnt lgkmcnt(1)
  v_smfmac_f32_16x16x64_bf16 v[56:59], v[12:15], a[40:47], v27
  s_add_u32 s6, s6, 8192
  s_addc_u32 s7, s7, 0
  global_load_dwordx4 v[208:211], v1, s[6:7] offset:-4096 sc1
  v_smfmac_f32_16x16x64_bf16 v[60:63], v[12:15], a[96:103], v27
  v_add_f32 v31, v31, |v109|
  v_smfmac_f32_16x16x64_bf16 v[64:67], v[12:15], a[152:159], v27
  global_load_dwordx4 v[212:215], v1, s[6:7] offset:-3072 sc1
  s_waitcnt lgkmcnt(0)
  v_smfmac_f32_16x16x64_bf16 v[56:59], v[16:19], a[48:55], v27
  v_add_f32 v31, v31, |v110|
  v_smfmac_f32_16x16x64_bf16 v[60:63], v[16:19], a[104:111], v27
  v_add_f32 v31, v31, |v111|
  v_smfmac_f32_16x16x64_bf16 v[64:67], v[16:19], a[160:167], v27
  v_add_f32 v31, v31, |v112|
  v_smfmac_f32_16x16x64_bf16 v[68:71], v[40:43], a[168:175], v27
  v_add_f32 v31, v31, |v113|
  s_waitcnt vmcnt(40)
  v_smfmac_f32_16x16x64_bf16 v[72:75], v[40:43], a[224:231], v27
  v_add_f32 v31, v31, |v114|
  v_smfmac_f32_16x16x64_bf16 v[68:71], v[44:47], a[176:183], v27
  v_add_f32 v31, v31, |v115|
  s_waitcnt vmcnt(38)
  v_smfmac_f32_16x16x64_bf16 v[72:75], v[44:47], a[232:239], v27
  v_add_f32 v31, v31, |v116|
  v_smfmac_f32_16x16x64_bf16 v[68:71], v[48:51], a[184:191], v27
  v_add_f32 v56, v56, v57
  s_waitcnt vmcnt(36)
  v_smfmac_f32_16x16x64_bf16 v[72:75], v[48:51], a[240:247], v27
  v_add_f32 v58, v58, v59
  v_smfmac_f32_16x16x64_bf16 v[68:71], v[52:55], a[192:199], v27
  v_cvt_pk_bf16_f32 v56, v56, v58
  s_waitcnt vmcnt(34)
  v_smfmac_f32_16x16x64_bf16 v[72:75], v[52:55], a[248:255], v27
  buffer_store_short v56, v33, s[40:43], s66 offen offset:192 sc1
  v_smfmac_f32_16x16x64_bf16 v[68:71], v[8:11], a[200:207], v27
  buffer_store_short_d16_hi v56, v33, s[40:43], s66 offen offset:1984 sc1
  s_waitcnt vmcnt(34)
  v_smfmac_f32_16x16x64_bf16 v[72:75], v[8:11], v[216:223], v27
  v_add_f32 v60, v60, v61
  v_smfmac_f32_16x16x64_bf16 v[68:71], v[12:15], a[208:215], v27
  v_add_f32 v62, v62, v63
  s_waitcnt vmcnt(32)
  v_smfmac_f32_16x16x64_bf16 v[72:75], v[12:15], v[224:231], v27
  v_add_f32 v64, v64, v65
  v_smfmac_f32_16x16x64_bf16 v[68:71], v[16:19], a[216:223], v27
  v_add_f32 v66, v66, v67
  s_waitcnt vmcnt(30)
  v_smfmac_f32_16x16x64_bf16 v[72:75], v[16:19], v[232:239], v27
  v_cvt_pk_bf16_f32 v88, v60, v64
  s_waitcnt vmcnt(28)
  v_smfmac_f32_16x16x64_bf16 v[76:79], v[40:43], v[240:247], v27
  v_cvt_pk_bf16_f32 v92, v62, v66
  s_waitcnt vmcnt(14)
  v_smfmac_f32_16x16x64_bf16 v[80:83], v[40:43], v[168:175], v27
  v_add_f32 v31, v31, |v117|
  v_smfmac_f32_16x16x64_bf16 v[76:79], v[44:47], v[248:255], v27
  v_add_f32 v31, v31, |v118|
  s_waitcnt vmcnt(12)
  v_smfmac_f32_16x16x64_bf16 v[80:83], v[44:47], v[184:191], v27
  v_add_f32 v31, v31, |v119|
  s_mov_b32 s67, 310378496
  s_mov_b32 s68, 1904214016
  s_mov_b32 s69, 226492416
  v_smfmac_f32_16x16x64_bf16 v[76:79], v[48:51], v[152:159], v27
  v_add_f32 v68, v68, v69
  s_waitcnt vmcnt(10)
  v_smfmac_f32_16x16x64_bf16 v[80:83], v[48:51], v[176:183], v27
  v_add_f32 v70, v70, v71
  v_smfmac_f32_16x16x64_bf16 v[76:79], v[52:55], v[160:167], v27
  v_add_f32 v72, v72, v73
  s_waitcnt vmcnt(8)
  v_smfmac_f32_16x16x64_bf16 v[80:83], v[52:55], v[200:207], v27
  v_add_f32 v74, v74, v75
  v_smfmac_f32_16x16x64_bf16 v[76:79], v[8:11], v[120:127], v27
  v_cvt_pk_bf16_f32 v89, v68, v72
  s_waitcnt vmcnt(6)
  v_smfmac_f32_16x16x64_bf16 v[80:83], v[8:11], v[144:151], v27
  v_cvt_pk_bf16_f32 v93, v70, v74
  v_smfmac_f32_16x16x64_bf16 v[76:79], v[12:15], v[128:135], v27
  v_cmp_nle_f32 s[56:57], s67, v30
  s_waitcnt vmcnt(4)
  v_smfmac_f32_16x16x64_bf16 v[80:83], v[12:15], v[192:199], v27
  v_cmp_nge_f32 s[58:59], s68, v30
  v_smfmac_f32_16x16x64_bf16 v[76:79], v[16:19], v[136:143], v27
  v_cmp_nle_f32 s[60:61], s69, v31
  s_mov_b32 s67, 0x7f800000
  s_waitcnt vmcnt(2)
  v_smfmac_f32_16x16x64_bf16 v[80:83], v[16:19], v[208:215], v27
  v_cmp_ngt_f32 vcc, s67, v31
  s_lshl_b32 s68, s3, 2
  v_mov_b32 v30, s68
  s_or_b64 s[56:57], s[56:57], s[58:59]
  s_or_b64 s[60:61], s[60:61], vcc
  s_or_b64 s[56:57], s[56:57], s[60:61]
  s_cselect_b32 s67, 1, 0
  v_mov_b32 v31, s67
  ds_write_b32 v30, v31 offset:57344
  v_add_f32 v76, v76, v77
  v_add_f32 v78, v78, v79
  v_add_f32 v80, v80, v81
  v_add_f32 v82, v82, v83
  v_cvt_pk_bf16_f32 v90, v76, v80
  v_cvt_pk_bf16_f32 v94, v78, v82
  buffer_store_dwordx3 v[88:90], v28, s[40:43], s66 offen sc1
  buffer_store_dwordx3 v[92:94], v28, s[40:43], s66 offen offset:1792 sc1
  v_mov_b32 v4, 0
  s_waitcnt lgkmcnt(0)
  s_barrier
  ds_read_b128 v[8:11], v4 offset:57344
  s_waitcnt lgkmcnt(0)
  v_or_b32 v8, v8, v9
  v_or3_b32 v8, v8, v10, v11
  s_nop 0
  v_readfirstlane_b32 s67, v8
  s_cmp_gt_u32 s67, s36
  s_cbranch_scc1 k_fallback
k_exit:
  s_endpgm
k_lead:
  s_mov_b64 s[52:53], s[28:29]
  s_mov_b32 s54, 5287936
  s_mov_b32 s55, 0x20000
  v_lshlrev_b32 v1, 4, v0
  v_mov_b64 v[48:49], 0
  v_mov_b64 v[50:51], 0
  v_lshlrev_b32 v52, 7, v0
  s_mov_b32 s39, 5242880
  buffer_store_dword v48, v52, s[52:55], s39 offen sc1
  s_mov_b32 s39, 5251072
  buffer_store_dword v48, v52, s[52:55], s39 offen sc1
  s_mov_b32 s39, 5259264
  buffer_store_dword v48, v52, s[52:55], s39 offen sc1
  s_mov_b32 s39, 5267456
  buffer_store_dword v48, v52, s[52:55], s39 offen sc1
  s_mov_b32 s39, 5275648
  buffer_store_dword v48, v52, s[52:55], s39 offen sc1
  s_mov_b32 s39, 5283840
  buffer_store_dwordx4 v[48:51], v1, s[52:55], s39 offen offset:0 sc1
  buffer_store_dwordx4 v[48:51], v1, s[52:55], s39 offen offset:1024 sc1
  buffer_store_dwordx4 v[48:51], v1, s[52:55], s39 offen offset:2048 sc1
  buffer_store_dwordx4 v[48:51], v1, s[52:55], s39 offen offset:3072 sc1
  s_branch k_nolead
k_init:
  s_mov_b32 s73, 0
k_init_l:
  v_mov_b32 v35, 0
  buffer_load_dword v35, v35, s[16:19], 0 offen sc1
  s_add_u32 s73, s73, 1
  s_cmp_gt_u32 s73, 20000
  s_waitcnt vmcnt(0)
  s_cbranch_scc1 k_initok
  v_cmp_ne_u32 vcc, 1, v35
  s_cbranch_vccnz k_init_l
  s_branch k_initok
k_wo:
  s_cmp_lt_u32 s30, 28
  s_cselect_b32 s50, 5287936, 0
  s_mov_b64 s[48:49], s[28:29]
  s_lshr_b32 s65, s30, 2
  s_and_b32 s66, s30, 3
  s_lshl1_add_u32 s65, s65, s72
  s_mul_i32 s16, s66, 98
  s_add_u32 s16, s16, s65
  s_lshl_b32 s16, s16, 10
  s_lshl4_add_u32 s17, s66, s65
  s_lshl_b32 s17, s17, 7
  s_add_u32 s17, s17, 5275648
  s_mov_b32 s74, 0x05040100
  s_mov_b32 s75, 0x07060302
  s_add_u32 m0, s64, 122880
  s_lshl_b32 s39, s33, 7
  s_add_u32 s39, s39, s67
  buffer_load_dwordx4 v12, s[56:59], s39 offen lds
  v_fma_f32 v69, v6, 2.0, v68
  v_fma_f32 v58, v6, 2.0, v57
  v_fma_f32 v62, v6, 2.0, v61
  v_fma_f32 v66, v6, 2.0, v65
  v_fma_f32 v70, v6, 2.0, v69
  v_fma_f32 v59, v6, 2.0, v58
  v_fma_f32 v63, v6, 2.0, v62
  v_fma_f32 v67, v6, 2.0, v66
  v_fma_f32 v71, v6, 2.0, v70
  v_bfe_u32 v4, v0, 3, 2
  buffer_load_dwordx4 v13, s[56:59], s39 offen offset:1024 lds
  v_mul_u32_u24 v4, 7, v4
  v_lshrrev_b32 v5, 5, v0
  v_add_u32 v4, v4, v5
  v_and_b32 v5, 7, v0
  v_lshlrev_b32 v5, 4, v5
  v_lshrrev_b32 v6, 2, v4
  v_lshl_add_u32 v7, v6, 8, v5
  v_and_b32 v6, 1, v4
  v_lshl_add_u32 v7, v6, 7, v7
  v_bfe_u32 v6, v4, 1, 1
  s_add_u32 m0, s64, 131072
  s_lshl_b32 s39, s34, 7
  s_add_u32 s39, s39, s67
  buffer_load_dwordx4 v12, s[56:59], s39 offen lds
  v_lshl_add_u32 v7, v6, 3, v7
  s_add_u32 s8, s3, 1
  s_and_b32 s4, s8, 3
  s_mul_i32 s8, s4, 1792
  s_add_u32 s8, s8, 65536
  v_add_u32 v40, s8, v7
  s_add_u32 s8, s3, 2
  s_and_b32 s5, s8, 3
  s_mul_i32 s8, s5, 1792
  s_add_u32 s8, s8, 65536
  buffer_load_dwordx4 v13, s[56:59], s39 offen offset:1024 lds
  v_add_u32 v42, s8, v7
  s_add_u32 s8, s3, 3
  s_and_b32 s6, s8, 3
  s_mul_i32 s8, s6, 1792
  s_add_u32 s8, s8, 65536
  v_add_u32 v44, s8, v7
  s_add_u32 s8, s3, 4
  s_and_b32 s7, s8, 3
  s_mul_i32 s8, s7, 1792
  s_add_u32 s8, s8, 65536
  s_add_u32 m0, s64, 139264
  s_lshl_b32 s39, s35, 7
  s_add_u32 s39, s39, s67
  buffer_load_dwordx4 v12, s[56:59], s39 offen lds
  v_add_u32 v46, s8, v7
  v_add_u32 v4, 2, v4
  v_lshrrev_b32 v6, 2, v4
  v_lshl_add_u32 v7, v6, 8, v5
  v_and_b32 v6, 1, v4
  v_lshl_add_u32 v7, v6, 7, v7
  v_bfe_u32 v6, v4, 1, 1
  v_lshl_add_u32 v7, v6, 3, v7
  s_mul_i32 s8, s4, 1792
  s_add_u32 s8, s8, 65536
  buffer_load_dwordx4 v13, s[56:59], s39 offen offset:1024 lds
  v_add_u32 v41, s8, v7
  s_mul_i32 s8, s5, 1792
  s_add_u32 s8, s8, 65536
  v_add_u32 v43, s8, v7
  s_mul_i32 s8, s6, 1792
  s_add_u32 s8, s8, 65536
  v_add_u32 v45, s8, v7
  s_mul_i32 s8, s7, 1792
  s_add_u32 s8, s8, 65536
  v_add_u32 v47, s8, v7
  s_add_u32 m0, s64, 147456
  s_lshl_b32 s39, s36, 7
  s_add_u32 s39, s39, s67
  buffer_load_dwordx4 v12, s[56:59], s39 offen lds
  s_lshl_b32 s8, s3, 11
  s_min_u32 s8, s8, 5120
  s_add_u32 s8, s8, 65536
  v_add_u32 v39, s8, v1
  s_mul_i32 s8, s3, 12288
  v_add_u32 v4, s8, v1
  s_mul_i32 s8, s6, 12288
  v_add_u32 v5, s8, v1
  s_mul_i32 s8, s5, 12288
  v_add_u32 v6, s8, v1
  buffer_load_dwordx4 v13, s[56:59], s39 offen offset:1024 lds
  s_mul_i32 s8, s4, 12288
  v_add_u32 v7, s8, v1
  v_and_b32 v104, 15, v0
  v_cvt_f32_u32 v104, v104
  v_mul_f32 v104, 1023410176, v104
  v_bfe_u32 v105, v0, 4, 2
  v_cvt_f32_u32 v105, v105
  v_mul_f32 v105, 4.0, v105
  v_mul_f32 v88, v104, v105
  v_mul_f32 v105, 4.0, v104
  s_add_u32 s20, s28, 5242880
  s_addc_u32 s21, s29, 0
  s_lshl3_add_u32 s26, s30, s31
  s_lshl_b32 s65, s3, 11
  s_min_u32 s65, s65, 5120
  s_mul_i32 s39, s26, 7168
  s_add_u32 s39, s39, s65
  s_add_u32 s22, s28, s39
  s_addc_u32 s23, s29, 0
  s_lshl_b32 s39, s3, 16
  s_add_u32 s39, s39, 2101248
  s_add_u32 s4, s28, s39
  s_addc_u32 s5, s29, 0
  s_mul_i32 s39, s3, 100352
  s_add_u32 s39, s39, 2363392
  s_add_u32 s6, s28, s39
  s_addc_u32 s7, s29, 0
  s_waitcnt vmcnt(8)
  s_barrier
  s_add_u32 m0, s64, 155648
  s_lshl_b32 s39, s37, 7
  s_add_u32 s39, s39, s67
  buffer_load_dwordx4 v12, s[56:59], s39 offen lds
  v_cos_f32 v72, v56
  v_sin_f32 v56, v56
  v_cos_f32 v73, v57
  v_sin_f32 v57, v57
  v_cos_f32 v74, v58
  buffer_load_dwordx4 v13, s[56:59], s39 offen offset:1024 lds
  v_sin_f32 v58, v58
  v_cos_f32 v75, v59
  v_sin_f32 v59, v59
  v_cos_f32 v76, v60
  v_sin_f32 v60, v60
  s_add_u32 m0, s64, 0
  s_lshl_b32 s39, s38, 7
  s_add_u32 s39, s39, s67
  buffer_load_dwordx4 v12, s[56:59], s39 offen lds
  v_cos_f32 v77, v61
  v_sin_f32 v61, v61
  v_cos_f32 v78, v62
  v_sin_f32 v62, v62
  v_cos_f32 v79, v63
  buffer_load_dwordx4 v13, s[56:59], s39 offen offset:1024 lds
  v_sin_f32 v63, v63
  v_cos_f32 v80, v64
  v_sin_f32 v64, v64
  v_cos_f32 v81, v65
  v_sin_f32 v65, v65
  s_cmp_lt_u32 s30, 28
  s_cselect_b32 s42, 401408, 0
  s_mul_i32 s42, s42, s71
  s_mov_b64 s[40:41], s[12:13]
  s_mov_b32 s43, 0x20000
  s_and_b32 s14, s30, 28
  s_add_u32 s14, s14, s72
  s_mul_i32 s14, s14, 14336
  s_and_b32 s15, s30, 3
  s_mul_i32 s15, s15, 224
  s_add_u32 s14, s14, s15
  s_add_u32 s15, s14, 28672
  v_lshrrev_b32 v152, 4, v0
  v_and_b32 v154, 15, v0
  v_mul_u32_u24 v152, 3584, v152
  v_mad_u32_u24 v153, v154, 12, v152
  v_lshl_add_u32 v152, v154, 1, v152
  buffer_load_dwordx3 v[120:122], v153, s[40:43], s14 offen offset:0
  buffer_load_ushort v123, v152, s[40:43], s14 offen offset:192
  buffer_load_dwordx3 v[124:126], v153, s[40:43], s14 offen offset:896
  buffer_load_ushort v127, v152, s[40:43], s14 offen offset:1088
  buffer_load_dwordx3 v[128:130], v153, s[40:43], s14 offen offset:1792
  buffer_load_ushort v131, v152, s[40:43], s14 offen offset:1984
  buffer_load_dwordx3 v[132:134], v153, s[40:43], s14 offen offset:2688
  buffer_load_ushort v135, v152, s[40:43], s14 offen offset:2880
  buffer_load_dwordx3 v[136:138], v153, s[40:43], s15 offen offset:0
  buffer_load_ushort v139, v152, s[40:43], s15 offen offset:192
  buffer_load_dwordx3 v[140:142], v153, s[40:43], s15 offen offset:896
  buffer_load_ushort v143, v152, s[40:43], s15 offen offset:1088
  buffer_load_dwordx3 v[144:146], v153, s[40:43], s15 offen offset:1792
  buffer_load_ushort v147, v152, s[40:43], s15 offen offset:1984
  buffer_load_dwordx3 v[148:150], v153, s[40:43], s15 offen offset:2688
  buffer_load_ushort v151, v152, s[40:43], s15 offen offset:2880
  s_waitcnt vmcnt(26)
  s_barrier
  s_and_b32 s65, s2, 7
  s_cmp_lt_u32 s65, 7
  s_cselect_b32 s46, 3670016, 0
  s_mov_b64 s[44:45], s[24:25]
  s_mov_b32 s47, 0x20000
  s_mov_b64 s[40:41], s[24:25]
  s_mov_b32 s42, 3670016
  s_mov_b32 s43, 0x20000
  s_lshl1_add_u32 s65, s65, s71
  s_waitcnt vmcnt(24)
  s_barrier
  s_min_u32 s65, s65, 13
  s_lshl3_add_u32 s27, s3, s31
  s_lshl_b32 s27, s27, 7
  s_lshl2_add_u32 s27, s30, s27
  s_add_u32 s27, s27, 5283840
  s_lshl_b32 s39, s65, 4
  s_sub_u32 s68, 209, s39
  s_cmp_ge_u32 s65, 7
  s_cselect_b32 s68, s68, s39
  s_cselect_b32 s67, -8, 0
  s_waitcnt vmcnt(22)
  s_barrier
  s_lshr_b32 s39, s2, 3
  s_lshl_b32 s39, s39, 16
  s_lshl3_add_u32 s68, s68, s39
  s_add_u32 s68, s68, 3149824
  s_add_u32 s67, s67, s68
  s_add_u32 s67, s67, 1024
  s_add_u32 s8, s28, s68
  s_addc_u32 s9, s29, 0
  s_add_u32 s10, s28, s67
  s_addc_u32 s11, s29, 0
  s_waitcnt vmcnt(20)
  s_barrier
  s_add_u32 s12, s8, 8192
  s_addc_u32 s13, s9, 0
  s_add_u32 s14, s10, 8192
  s_addc_u32 s15, s11, 0
  s_cmp_ge_u32 s65, 7
  s_cselect_b32 s64, -1, 1
  s_cselect_b32 s66, 2007040, 0
  s_mul_i32 s39, s64, 57344
  s_add_u32 s57, s39, s66
  s_mul_i32 s39, s64, 114688
  v_cos_f32 v82, v66
  v_sin_f32 v66, v66
  v_cos_f32 v83, v67
  v_sin_f32 v67, v67
  v_cos_f32 v84, v68
  v_sin_f32 v68, v68
  v_cos_f32 v85, v69
  v_sin_f32 v69, v69
  v_cos_f32 v86, v70
  v_sin_f32 v70, v70
  v_cos_f32 v87, v71
  v_sin_f32 v71, v71
  v_cvt_pk_bf16_f32 v216, v72, v56
  v_cvt_pk_bf16_f32 v217, v73, v57
  v_cvt_pk_bf16_f32 v218, v74, v58
  v_cvt_pk_bf16_f32 v219, v75, v59
  v_cvt_pk_bf16_f32 v220, v76, v60
  v_cvt_pk_bf16_f32 v221, v77, v61
  v_cvt_pk_bf16_f32 v222, v78, v62
  v_cvt_pk_bf16_f32 v223, v79, v63
  v_cvt_pk_bf16_f32 v224, v80, v64
  v_cvt_pk_bf16_f32 v225, v81, v65
  v_cvt_pk_bf16_f32 v226, v82, v66
  v_cvt_pk_bf16_f32 v227, v83, v67
  v_cvt_pk_bf16_f32 v228, v84, v68
  v_cvt_pk_bf16_f32 v229, v85, v69
  v_cvt_pk_bf16_f32 v230, v86, v70
  v_cvt_pk_bf16_f32 v231, v87, v71
  v_mov_b64 v[56:57], 0
  v_mov_b64 v[58:59], 0
  v_mov_b64 v[60:61], 0
  v_mov_b64 v[62:63], 0
  v_mov_b64 v[64:65], 0
  v_mov_b64 v[66:67], 0
  v_mov_b64 v[68:69], 0
  v_mov_b64 v[70:71], 0
  v_mov_b64 v[72:73], 0
  v_mov_b64 v[74:75], 0
  v_mov_b64 v[76:77], 0
  v_mov_b64 v[78:79], 0
  v_mov_b64 v[80:81], 0
  v_mov_b64 v[82:83], 0
  v_mov_b64 v[84:85], 0
  v_mov_b64 v[86:87], 0
  v_mov_b64 v[88:89], 0
  v_mov_b64 v[90:91], 0
  v_mov_b64 v[92:93], 0
  v_mov_b64 v[94:95], 0
  v_mov_b64 v[96:97], 0
  v_mov_b64 v[98:99], 0
  v_mov_b64 v[100:101], 0
  v_mov_b64 v[102:103], 0
  v_mov_b64 v[104:105], 0
  v_mov_b64 v[106:107], 0
  v_mov_b64 v[108:109], 0
  v_mov_b64 v[110:111], 0
  v_mov_b64 v[112:113], 0
  v_mov_b64 v[114:115], 0
  v_mov_b64 v[116:117], 0
  v_mov_b64 v[118:119], 0
  s_add_u32 s58, s39, s66
  s_mul_i32 s39, s64, 172032
  s_add_u32 s59, s39, s66
  s_mul_i32 s39, s64, 1835008
  s_add_u32 s60, s39, s66
  s_mul_i32 s39, s64, 1892352
  s_add_u32 s61, s39, s66
  s_mul_i32 s39, s64, 1949696
  s_add_u32 s62, s39, s66
  s_mul_i32 s39, s64, 2007040
  s_add_u32 s63, s39, s66
  s_bfe_u32 s69, s30, 0x20001
  s_lshl2_add_u32 s69, s69, 768
  s_lshr_b32 s39, s30, 3
  s_add_u32 s69, s69, s39
  s_and_b32 s39, s30, 1
  s_lshl1_add_u32 s69, s69, s39
  s_lshl4_add_u32 s69, s69, s31
  s_lshl_b32 s69, s69, 7
  s_lshl_b32 s39, s3, 19
  s_add_u32 s69, s69, s39
  s_add_u32 s70, s69, 262144
  s_waitcnt vmcnt(7)
  v_perm_b32 v176, v136, v120, s74
  s_waitcnt vmcnt(5)
  v_perm_b32 v177, v140, v124, s74
  s_waitcnt vmcnt(3)
  v_perm_b32 v178, v144, v128, s74
  s_waitcnt vmcnt(1)
  v_perm_b32 v179, v148, v132, s74
  s_add_u32 s18, s16, 2373632
  buffer_store_dwordx4 v[176:179], v1, s[48:51], s18 offen sc1
  v_perm_b32 v180, v136, v120, s75
  v_perm_b32 v181, v140, v124, s75
  v_perm_b32 v182, v144, v128, s75
  v_perm_b32 v183, v148, v132, s75
  s_add_u32 s18, s16, 2387968
  buffer_store_dwordx4 v[180:183], v1, s[48:51], s18 offen sc1
  v_perm_b32 v184, v137, v121, s74
  v_perm_b32 v185, v141, v125, s74
  v_perm_b32 v186, v145, v129, s74
  v_perm_b32 v187, v149, v133, s74
  s_add_u32 s18, s16, 2402304
  buffer_store_dwordx4 v[184:187], v1, s[48:51], s18 offen sc1
  v_perm_b32 v188, v137, v121, s75
  v_perm_b32 v189, v141, v125, s75
  v_perm_b32 v190, v145, v129, s75
  v_perm_b32 v191, v149, v133, s75
  s_add_u32 s18, s16, 2416640
  buffer_store_dwordx4 v[188:191], v1, s[48:51], s18 offen sc1
  v_perm_b32 v192, v138, v122, s74
  v_perm_b32 v193, v142, v126, s74
  v_perm_b32 v194, v146, v130, s74
  v_perm_b32 v195, v150, v134, s74
  s_add_u32 s18, s16, 2430976
  buffer_store_dwordx4 v[192:195], v1, s[48:51], s18 offen sc1
  v_perm_b32 v196, v138, v122, s75
  v_perm_b32 v197, v142, v126, s75
  v_perm_b32 v198, v146, v130, s75
  v_perm_b32 v199, v150, v134, s75
  s_add_u32 s18, s16, 2445312
  buffer_store_dwordx4 v[196:199], v1, s[48:51], s18 offen sc1
  v_perm_b32 v176, v139, v123, s74
  v_perm_b32 v177, v143, v127, s74
  v_perm_b32 v178, v147, v131, s74
  s_waitcnt vmcnt(6)
  v_perm_b32 v179, v151, v135, s74
  s_add_u32 s18, s16, 2359296
  buffer_store_dwordx4 v[176:179], v1, s[48:51], s18 offen sc1
  global_load_dword v253, v3, s[20:21] sc1
  s_barrier
  s_barrier
  s_waitcnt vmcnt(0)
  v_cmp_ne_u32 vcc, 1, v253
  s_cbranch_vccz k_pollw_ok
k_pollw:
  s_mov_b32 s73, 0
k_pollw_l:
  global_load_dword v253, v3, s[20:21] sc1
  s_add_u32 s73, s73, 1
  s_cmp_gt_u32 s73, 20000
  s_waitcnt vmcnt(0)
  s_cbranch_scc1 k_pollw_ok
  v_cmp_ne_u32 vcc, 1, v253
  s_cbranch_vccnz k_pollw_l
  s_branch k_pollw_ok
k_pollw_ok:
  buffer_store_dword v255, v254, s[48:51], s17 offen sc1
  global_load_dwordx4 v[48:51], v1, s[22:23] offset:0 sc1
  global_load_dwordx4 v[52:55], v1, s[22:23] offset:1024 sc1
  global_load_dwordx4 v[152:155], v1, s[4:5] offset:-4096 sc1
  global_load_dwordx4 v[156:159], v1, s[4:5] offset:-3072 sc1
  global_load_dwordx4 v[160:163], v1, s[4:5] offset:-2048 sc1
  global_load_dwordx4 v[164:167], v1, s[4:5] offset:-1024 sc1
  global_load_dwordx4 v[168:171], v1, s[4:5] offset:0 sc1
  global_load_dwordx4 v[172:175], v1, s[4:5] offset:1024 sc1
  v_mov_b32 v3, v37
  s_branch k_join
k_wwait:
  s_mov_b32 s73, 0
k_wwait_l:
  global_load_dword v253, v251, s[20:21] sc1
  s_add_u32 s73, s73, 1
  s_cmp_gt_u32 s73, 20000
  s_waitcnt vmcnt(0)
  s_cbranch_scc1 k_wwait_ok
  v_cmp_ne_u32 vcc, 1, v253
  s_cbranch_vccnz k_wwait_l
  s_branch k_wwait_ok
k_uwait:
  s_mov_b32 s73, 0
k_uwait_l:
  global_load_dword v253, v252, s[20:21] sc1
  s_add_u32 s73, s73, 1
  s_cmp_gt_u32 s73, 20000
  s_waitcnt vmcnt(0)
  s_cbranch_scc1 k_uwait_ok
  v_cmp_ne_u32 vcc, 1, v253
  s_cbranch_vccnz k_uwait_l
  s_branch k_uwait_ok
k_kv:
  s_cmp_eq_u32 s72, 1
  s_cbranch_scc1 k_v
  s_lshl1_add_u32 s69, s30, s71
  s_lshl_b32 s69, s69, 12
  s_add_u32 s69, s69, 2097152
  v_mov_b32 v31, 0x3f803f80
  v_and_b32 v34, 0x33, v0
  v_bfe_u32 v253, v0, 2, 1
  v_lshl_add_u32 v34, v253, 3, v34
  v_bfe_u32 v253, v0, 3, 1
  v_lshl_add_u32 v34, v253, 2, v34
  v_lshlrev_b32 v34, 4, v34
  s_mov_b32 s74, 1049335798
  s_mov_b32 s75, 1049335798
  v_mov_b32 v253, 0x3f80
  v_cmp_lt_u32 s[22:23], 31, v0
  s_add_u32 m0, s14, 32768
  s_mul_i32 s39, s34, s20
  s_add_u32 s39, s39, s66
  buffer_load_dwordx4 v10, s[44:47], s39 offen lds
  s_add_u32 m0, s15, 32768
  s_nop 0
  buffer_load_dwordx4 v11, s[48:51], s39 offen lds
  s_add_u32 m0, s64, 49152
  s_lshl_b32 s39, s35, 7
  s_add_u32 s39, s39, s65
  buffer_load_dwordx4 v8, s[40:43], s39 offen lds
  buffer_load_dwordx4 v9, s[40:43], s39 offen offset:1024 lds
  s_add_u32 m0, s14, 49152
  s_mul_i32 s39, s35, s20
  s_add_u32 s39, s39, s66
  buffer_load_dwordx4 v10, s[44:47], s39 offen lds
  s_add_u32 m0, s15, 49152
  s_nop 0
  buffer_load_dwordx4 v11, s[48:51], s39 offen lds
  s_waitcnt vmcnt(12)
  s_barrier
  ds_read_b128 a[0:3], v16 offset:0
  ds_read_b64_tr_b16 a[32:33], v24 offset:8192
  ds_read_b64_tr_b16 a[34:35], v24 offset:8416
  s_add_u32 m0, s64, 65536
  s_lshl_b32 s39, s36, 7
  s_add_u32 s39, s39, s65
  buffer_load_dwordx4 v8, s[40:43], s39 offen lds
  ds_read_b128 a[4:7], v17 offset:0
  ds_read_b64_tr_b16 a[36:37], v24 offset:9088
  ds_read_b64_tr_b16 a[38:39], v24 offset:9312
  buffer_load_dwordx4 v9, s[40:43], s39 offen offset:1024 lds
  ds_read_b128 a[8:11], v18 offset:0
  ds_read_b64_tr_b16 a[40:41], v24 offset:9984
  ds_read_b64_tr_b16 a[42:43], v24 offset:10208
  s_add_u32 m0, s14, 65536
  s_mul_i32 s39, s36, s20
  s_add_u32 s39, s39, s66
  buffer_load_dwordx4 v10, s[44:47], s39 offen lds
  ds_read_b128 a[12:15], v19 offset:0
  ds_read_b64_tr_b16 a[44:45], v24 offset:10880
  ds_read_b64_tr_b16 a[46:47], v24 offset:11104
  s_add_u32 m0, s15, 65536
  s_nop 0
  buffer_load_dwordx4 v11, s[48:51], s39 offen lds
  s_waitcnt vmcnt(12)
  s_barrier
  ds_read_b128 a[16:19], v16 offset:16384
  ds_read_b64_tr_b16 a[48:49], v24 offset:24576
  ds_read_b64_tr_b16 a[50:51], v24 offset:24800
  s_add_u32 m0, s64, 81920
  s_lshl_b32 s39, s37, 7
  s_add_u32 s39, s39, s65
  s_waitcnt lgkmcnt(12)
  v_mfma_f32_32x32x16_bf16 v[200:215], a[32:35], a[0:3], 0
  buffer_load_dwordx4 v8, s[40:43], s39 offen lds
  ds_read_b128 a[20:23], v17 offset:16384
  ds_read_b64_tr_b16 a[52:53], v24 offset:25472
  ds_read_b64_tr_b16 a[54:55], v24 offset:25696
  s_waitcnt lgkmcnt(12)
  v_mfma_f32_32x32x16_bf16 v[200:215], a[36:39], a[4:7], v[200:215]
  buffer_load_dwordx4 v9, s[40:43], s39 offen offset:1024 lds
  ds_read_b128 a[24:27], v18 offset:16384
  ds_read_b64_tr_b16 a[56:57], v24 offset:26368
  ds_read_b64_tr_b16 a[58:59], v24 offset:26592
  s_add_u32 m0, s14, 81920
  s_mul_i32 s39, s37, s20
  s_add_u32 s39, s39, s66
  s_waitcnt lgkmcnt(12)
  v_mfma_f32_32x32x16_bf16 v[200:215], a[40:43], a[8:11], v[200:215]
  buffer_load_dwordx4 v10, s[44:47], s39 offen lds
  ds_read_b128 a[28:31], v19 offset:16384
  ds_read_b64_tr_b16 a[60:61], v24 offset:27264
  ds_read_b64_tr_b16 a[62:63], v24 offset:27488
  s_add_u32 m0, s15, 81920
  s_waitcnt lgkmcnt(12)
  v_mfma_f32_32x32x16_bf16 v[200:215], a[44:47], a[12:15], v[200:215]
  buffer_load_dwordx4 v11, s[48:51], s39 offen lds
  s_waitcnt vmcnt(12)
  s_barrier
  ds_read_b128 a[0:3], v16 offset:32768
  ds_read_b64_tr_b16 a[32:33], v24 offset:40960
  ds_read_b64_tr_b16 a[34:35], v24 offset:41184
  s_add_u32 m0, s64, 98304
  s_lshl_b32 s39, s38, 7
  s_add_u32 s39, s39, s65
  s_waitcnt lgkmcnt(12)
  v_mfma_f32_32x32x16_bf16 v[200:215], a[48:51], a[16:19], v[200:215]
  buffer_load_dwordx4 v8, s[40:43], s39 offen lds
  ds_read_b128 a[4:7], v17 offset:32768
  ds_read_b64_tr_b16 a[36:37], v24 offset:41856
  ds_read_b64_tr_b16 a[38:39], v24 offset:42080
  s_waitcnt lgkmcnt(12)
  v_mfma_f32_32x32x16_bf16 v[200:215], a[52:55], a[20:23], v[200:215]
  buffer_load_dwordx4 v9, s[40:43], s39 offen offset:1024 lds
  ds_read_b128 a[8:11], v18 offset:32768
  ds_read_b64_tr_b16 a[40:41], v24 offset:42752
  ds_read_b64_tr_b16 a[42:43], v24 offset:42976
  s_add_u32 m0, s14, 98304
  s_mul_i32 s39, s38, s20
  s_add_u32 s39, s39, s66
  s_waitcnt lgkmcnt(12)
  v_mfma_f32_32x32x16_bf16 v[200:215], a[56:59], a[24:27], v[200:215]
  buffer_load_dwordx4 v10, s[44:47], s39 offen lds
  ds_read_b128 a[12:15], v19 offset:32768
  ds_read_b64_tr_b16 a[44:45], v24 offset:43648
  ds_read_b64_tr_b16 a[46:47], v24 offset:43872
  s_add_u32 m0, s15, 98304
  s_waitcnt lgkmcnt(12)
  v_mfma_f32_32x32x16_bf16 v[200:215], a[60:63], a[28:31], v[200:215]
  buffer_load_dwordx4 v11, s[48:51], s39 offen lds
  s_waitcnt vmcnt(12)
  s_barrier
  ds_read_b128 a[16:19], v16 offset:49152
  ds_read_b64_tr_b16 a[48:49], v24 offset:57344
  ds_read_b64_tr_b16 a[50:51], v24 offset:57568
  s_lshr_b32 s39, s2, 3
  s_lshl2_add_u32 s39, s39, s3
  v_lshrrev_b32 v14, 4, v0
  v_lshl_add_u32 v14, s39, 2, v14
  s_and_b32 s39, s2, 7
  s_mul_i32 s39, s39, 448
  v_min_u32 v14, 447, v14
  v_add_lshl_u32 v14, v14, s39, 7
  v_min_u32 v14, 401280, v14
  s_waitcnt lgkmcnt(12)
  v_mfma_f32_32x32x16_bf16 v[200:215], a[32:35], a[0:3], v[200:215]
  global_load_dword v15, v14, s[12:13]
  ds_read_b128 a[20:23], v17 offset:49152
  ds_read_b64_tr_b16 a[52:53], v24 offset:58240
  ds_read_b64_tr_b16 a[54:55], v24 offset:58464
  s_add_u32 m0, s64, 114688
  s_lshl_b32 s39, s32, 7
  s_add_u32 s39, s39, s67
  s_waitcnt lgkmcnt(12)
  v_mfma_f32_32x32x16_bf16 v[200:215], a[36:39], a[4:7], v[200:215]
  buffer_load_dwordx4 v12, s[56:59], s39 offen lds
  ds_read_b128 a[24:27], v18 offset:49152
  ds_read_b64_tr_b16 a[56:57], v24 offset:59136
  ds_read_b64_tr_b16 a[58:59], v24 offset:59360
  s_waitcnt lgkmcnt(12)
  v_mfma_f32_32x32x16_bf16 v[200:215], a[40:43], a[8:11], v[200:215]
  buffer_load_dwordx4 v13, s[56:59], s39 offen offset:1024 lds
  ds_read_b128 a[28:31], v19 offset:49152
  ds_read_b64_tr_b16 a[60:61], v24 offset:60032
  ds_read_b64_tr_b16 a[62:63], v24 offset:60256
  s_waitcnt lgkmcnt(12)
  v_mfma_f32_32x32x16_bf16 v[200:215], a[44:47], a[12:15], v[200:215]
  s_waitcnt vmcnt(11)
  s_barrier
  ds_read_b128 a[0:3], v20 offset:0
  ds_read_b64_tr_b16 a[32:33], v25 offset:8192
  ds_read_b64_tr_b16 a[34:35], v25 offset:8416
  s_waitcnt lgkmcnt(12)
  v_mfma_f32_32x32x16_bf16 v[200:215], a[48:51], a[16:19], v[200:215]
  ds_read_b128 a[4:7], v21 offset:0
  ds_read_b64_tr_b16 a[36:37], v25 offset:9088
  ds_read_b64_tr_b16 a[38:39], v25 offset:9312
  s_waitcnt lgkmcnt(12)
  v_mfma_f32_32x32x16_bf16 v[200:215], a[52:55], a[20:23], v[200:215]
  ds_read_b128 a[8:11], v22 offset:0
  ds_read_b64_tr_b16 a[40:41], v25 offset:9984
  ds_read_b64_tr_b16 a[42:43], v25 offset:10208
  s_waitcnt lgkmcnt(12)
  v_mfma_f32_32x32x16_bf16 v[200:215], a[56:59], a[24:27], v[200:215]
  ds_read_b128 a[12:15], v23 offset:0
  ds_read_b64_tr_b16 a[44:45], v25 offset:10880
  ds_read_b64_tr_b16 a[46:47], v25 offset:11104
  s_waitcnt lgkmcnt(12)
  v_mfma_f32_32x32x16_bf16 v[200:215], a[60:63], a[28:31], v[200:215]
  s_waitcnt vmcnt(7)
  s_barrier
  ds_read_b128 a[16:19], v20 offset:16384
  ds_read_b64_tr_b16 a[48:49], v25 offset:24576
  ds_read_b64_tr_b16 a[50:51], v25 offset:24800
  s_waitcnt lgkmcnt(12)
  v_mfma_f32_32x32x16_bf16 v[200:215], a[32:35], a[0:3], v[200:215]
  ds_read_b128 a[20:23], v21 offset:16384
  ds_read_b64_tr_b16 a[52:53], v25 offset:25472
  ds_read_b64_tr_b16 a[54:55], v25 offset:25696
  s_waitcnt lgkmcnt(12)
  v_mfma_f32_32x32x16_bf16 v[200:215], a[36:39], a[4:7], v[200:215]
  ds_read_b128 a[24:27], v22 offset:16384
  ds_read_b64_tr_b16 a[56:57], v25 offset:26368
  ds_read_b64_tr_b16 a[58:59], v25 offset:26592
  s_waitcnt lgkmcnt(12)
  v_mfma_f32_32x32x16_bf16 v[200:215], a[40:43], a[8:11], v[200:215]
  ds_read_b128 a[28:31], v23 offset:16384
  ds_read_b64_tr_b16 a[60:61], v25 offset:27264
  ds_read_b64_tr_b16 a[62:63], v25 offset:27488
  s_waitcnt lgkmcnt(12)
  v_mfma_f32_32x32x16_bf16 v[200:215], a[44:47], a[12:15], v[200:215]
  s_waitcnt vmcnt(3)
  s_barrier
  ds_read_b128 a[0:3], v20 offset:32768
  ds_read_b64_tr_b16 a[32:33], v25 offset:40960
  ds_read_b64_tr_b16 a[34:35], v25 offset:41184
  s_waitcnt lgkmcnt(12)
  v_mfma_f32_32x32x16_bf16 v[200:215], a[48:51], a[16:19], v[200:215]
  ds_read_b128 a[4:7], v21 offset:32768
  ds_read_b64_tr_b16 a[36:37], v25 offset:41856
  ds_read_b64_tr_b16 a[38:39], v25 offset:42080
  s_waitcnt lgkmcnt(12)
  v_mfma_f32_32x32x16_bf16 v[200:215], a[52:55], a[20:23], v[200:215]
  ds_read_b128 a[8:11], v22 offset:32768
  ds_read_b64_tr_b16 a[40:41], v25 offset:42752
  ds_read_b64_tr_b16 a[42:43], v25 offset:42976
  s_waitcnt lgkmcnt(12)
  v_mfma_f32_32x32x16_bf16 v[200:215], a[56:59], a[24:27], v[200:215]
  ds_read_b128 a[12:15], v23 offset:32768
  ds_read_b64_tr_b16 a[44:45], v25 offset:43648
  ds_read_b64_tr_b16 a[46:47], v25 offset:43872
  s_waitcnt lgkmcnt(12)
  v_mfma_f32_32x32x16_bf16 v[200:215], a[60:63], a[28:31], v[200:215]
  s_waitcnt lgkmcnt(9)
  v_mfma_f32_32x32x16_bf16 v[200:215], a[32:35], a[0:3], v[200:215]
  s_waitcnt lgkmcnt(6)
  v_mfma_f32_32x32x16_bf16 v[200:215], a[36:39], a[4:7], v[200:215]
  s_waitcnt lgkmcnt(3)
  v_mfma_f32_32x32x16_bf16 v[200:215], a[40:43], a[8:11], v[200:215]
  s_waitcnt lgkmcnt(0)
  v_mfma_f32_32x32x16_bf16 v[200:215], a[44:47], a[12:15], v[200:215]
  s_nop 11
  v_pk_mul_f32 v[200:201], v[200:201], s[74:75]
  v_pk_mul_f32 v[202:203], v[202:203], s[74:75]
  v_pk_mul_f32 v[204:205], v[204:205], s[74:75]
  v_pk_mul_f32 v[206:207], v[206:207], s[74:75]
  v_pk_mul_f32 v[208:209], v[208:209], s[74:75]
  v_pk_mul_f32 v[210:211], v[210:211], s[74:75]
  v_pk_mul_f32 v[212:213], v[212:213], s[74:75]
  v_pk_mul_f32 v[214:215], v[214:215], s[74:75]
  v_cvt_pk_bf16_f32 v48, v200, v201
  v_cvt_pk_bf16_f32 v49, v202, v203
  v_cvt_pk_bf16_f32 v50, v204, v205
  v_cvt_pk_bf16_f32 v51, v206, v207
  buffer_store_dwordx4 v[48:51], v34, s[52:55], s69 offen offset:0 sc1
  v_cvt_pk_bf16_f32 v52, v208, v209
  v_cvt_pk_bf16_f32 v53, v210, v211
  v_cvt_pk_bf16_f32 v54, v212, v213
  v_cvt_pk_bf16_f32 v55, v214, v215
  v_cndmask_b32 v54, v54, v31, s[22:23]
  v_cndmask_b32 v55, v55, v253, s[22:23]
  buffer_store_dwordx4 v[52:55], v34, s[52:55], s69 offen offset:1024 sc1
  buffer_load_dword v35, v35, s[16:19], 0 offen sc1
  s_branch k_p1b
k_v:
  s_lshl1_add_u32 s69, s30, s71
  s_lshl_b32 s69, s69, 12
  s_add_u32 s69, s69, 2097152
  v_mov_b32 v31, 0x3f803f80
  v_and_b32 v253, 31, v0
  v_cmp_eq_u32 s[22:23], 28, v253
  s_nop 1
  v_cndmask_b32 v31, 0, v31, s[22:23]
  v_cmp_lt_u32 s[22:23], 27, v253
  s_add_u32 m0, s14, 32768
  s_mul_i32 s39, s34, s20
  s_add_u32 s39, s39, s66
  buffer_load_dwordx4 v10, s[44:47], s39 offen lds
  s_add_u32 m0, s15, 32768
  s_nop 0
  buffer_load_dwordx4 v11, s[48:51], s39 offen lds
  s_add_u32 m0, s64, 49152
  s_lshl_b32 s39, s35, 7
  s_add_u32 s39, s39, s65
  buffer_load_dwordx4 v8, s[40:43], s39 offen lds
  buffer_load_dwordx4 v9, s[40:43], s39 offen offset:1024 lds
  s_add_u32 m0, s14, 49152
  s_mul_i32 s39, s35, s20
  s_add_u32 s39, s39, s66
  buffer_load_dwordx4 v10, s[44:47], s39 offen lds
  s_add_u32 m0, s15, 49152
  s_nop 0
  buffer_load_dwordx4 v11, s[48:51], s39 offen lds
  s_waitcnt vmcnt(12)
  s_barrier
  ds_read_b128 a[0:3], v16 offset:0
  ds_read_b64_tr_b16 a[32:33], v24 offset:12288
  ds_read_b64_tr_b16 a[34:35], v24 offset:12512
  s_add_u32 m0, s64, 65536
  s_lshl_b32 s39, s36, 7
  s_add_u32 s39, s39, s65
  buffer_load_dwordx4 v8, s[40:43], s39 offen lds
  ds_read_b128 a[4:7], v17 offset:0
  ds_read_b64_tr_b16 a[36:37], v24 offset:13184
  ds_read_b64_tr_b16 a[38:39], v24 offset:13408
  buffer_load_dwordx4 v9, s[40:43], s39 offen offset:1024 lds
  ds_read_b128 a[8:11], v18 offset:0
  ds_read_b64_tr_b16 a[40:41], v24 offset:14080
  ds_read_b64_tr_b16 a[42:43], v24 offset:14304
  s_add_u32 m0, s14, 65536
  s_mul_i32 s39, s36, s20
  s_add_u32 s39, s39, s66
  buffer_load_dwordx4 v10, s[44:47], s39 offen lds
  ds_read_b128 a[12:15], v19 offset:0
  ds_read_b64_tr_b16 a[44:45], v24 offset:14976
  ds_read_b64_tr_b16 a[46:47], v24 offset:15200
  s_add_u32 m0, s15, 65536
  s_nop 0
  buffer_load_dwordx4 v11, s[48:51], s39 offen lds
  s_waitcnt vmcnt(12)
  s_barrier
  ds_read_b128 a[16:19], v16 offset:16384
  ds_read_b64_tr_b16 a[48:49], v24 offset:28672
  ds_read_b64_tr_b16 a[50:51], v24 offset:28896
  s_add_u32 m0, s64, 81920
  s_lshl_b32 s39, s37, 7
  s_add_u32 s39, s39, s65
  s_waitcnt lgkmcnt(12)
  v_mfma_f32_32x32x16_bf16 v[200:215], a[0:3], a[32:35], 0
  buffer_load_dwordx4 v8, s[40:43], s39 offen lds
  ds_read_b128 a[20:23], v17 offset:16384
  ds_read_b64_tr_b16 a[52:53], v24 offset:29568
  ds_read_b64_tr_b16 a[54:55], v24 offset:29792
  s_waitcnt lgkmcnt(12)
  v_mfma_f32_32x32x16_bf16 v[200:215], a[4:7], a[36:39], v[200:215]
  buffer_load_dwordx4 v9, s[40:43], s39 offen offset:1024 lds
  ds_read_b128 a[24:27], v18 offset:16384
  ds_read_b64_tr_b16 a[56:57], v24 offset:30464
  ds_read_b64_tr_b16 a[58:59], v24 offset:30688
  s_add_u32 m0, s14, 81920
  s_mul_i32 s39, s37, s20
  s_add_u32 s39, s39, s66
  s_waitcnt lgkmcnt(12)
  v_mfma_f32_32x32x16_bf16 v[200:215], a[8:11], a[40:43], v[200:215]
  buffer_load_dwordx4 v10, s[44:47], s39 offen lds
  ds_read_b128 a[28:31], v19 offset:16384
  ds_read_b64_tr_b16 a[60:61], v24 offset:31360
  ds_read_b64_tr_b16 a[62:63], v24 offset:31584
  s_add_u32 m0, s15, 81920
  s_waitcnt lgkmcnt(12)
  v_mfma_f32_32x32x16_bf16 v[200:215], a[12:15], a[44:47], v[200:215]
  buffer_load_dwordx4 v11, s[48:51], s39 offen lds
  s_waitcnt vmcnt(12)
  s_barrier
  ds_read_b128 a[0:3], v16 offset:32768
  ds_read_b64_tr_b16 a[32:33], v24 offset:45056
  ds_read_b64_tr_b16 a[34:35], v24 offset:45280
  s_add_u32 m0, s64, 98304
  s_lshl_b32 s39, s38, 7
  s_add_u32 s39, s39, s65
  s_waitcnt lgkmcnt(12)
  v_mfma_f32_32x32x16_bf16 v[200:215], a[16:19], a[48:51], v[200:215]
  buffer_load_dwordx4 v8, s[40:43], s39 offen lds
  ds_read_b128 a[4:7], v17 offset:32768
  ds_read_b64_tr_b16 a[36:37], v24 offset:45952
  ds_read_b64_tr_b16 a[38:39], v24 offset:46176
  s_waitcnt lgkmcnt(12)
  v_mfma_f32_32x32x16_bf16 v[200:215], a[20:23], a[52:55], v[200:215]
  buffer_load_dwordx4 v9, s[40:43], s39 offen offset:1024 lds
  ds_read_b128 a[8:11], v18 offset:32768
  ds_read_b64_tr_b16 a[40:41], v24 offset:46848
  ds_read_b64_tr_b16 a[42:43], v24 offset:47072
  s_add_u32 m0, s14, 98304
  s_mul_i32 s39, s38, s20
  s_add_u32 s39, s39, s66
  s_waitcnt lgkmcnt(12)
  v_mfma_f32_32x32x16_bf16 v[200:215], a[24:27], a[56:59], v[200:215]
  buffer_load_dwordx4 v10, s[44:47], s39 offen lds
  ds_read_b128 a[12:15], v19 offset:32768
  ds_read_b64_tr_b16 a[44:45], v24 offset:47744
  ds_read_b64_tr_b16 a[46:47], v24 offset:47968
  s_add_u32 m0, s15, 98304
  s_waitcnt lgkmcnt(12)
  v_mfma_f32_32x32x16_bf16 v[200:215], a[28:31], a[60:63], v[200:215]
  buffer_load_dwordx4 v11, s[48:51], s39 offen lds
  s_waitcnt vmcnt(12)
  s_barrier
  ds_read_b128 a[16:19], v16 offset:49152
  ds_read_b64_tr_b16 a[48:49], v24 offset:61440
  ds_read_b64_tr_b16 a[50:51], v24 offset:61664
  s_lshr_b32 s39, s2, 3
  s_lshl2_add_u32 s39, s39, s3
  v_lshrrev_b32 v14, 4, v0
  v_lshl_add_u32 v14, s39, 2, v14
  s_and_b32 s39, s2, 7
  s_mul_i32 s39, s39, 448
  v_min_u32 v14, 447, v14
  v_add_lshl_u32 v14, v14, s39, 7
  v_min_u32 v14, 401280, v14
  s_waitcnt lgkmcnt(12)
  v_mfma_f32_32x32x16_bf16 v[200:215], a[0:3], a[32:35], v[200:215]
  global_load_dword v15, v14, s[12:13]
  ds_read_b128 a[20:23], v17 offset:49152
  ds_read_b64_tr_b16 a[52:53], v24 offset:62336
  ds_read_b64_tr_b16 a[54:55], v24 offset:62560
  s_add_u32 m0, s64, 114688
  s_lshl_b32 s39, s32, 7
  s_add_u32 s39, s39, s67
  s_waitcnt lgkmcnt(12)
  v_mfma_f32_32x32x16_bf16 v[200:215], a[4:7], a[36:39], v[200:215]
  buffer_load_dwordx4 v12, s[56:59], s39 offen lds
  ds_read_b128 a[24:27], v18 offset:49152
  ds_read_b64_tr_b16 a[56:57], v24 offset:63232
  ds_read_b64_tr_b16 a[58:59], v24 offset:63456
  s_waitcnt lgkmcnt(12)
  v_mfma_f32_32x32x16_bf16 v[200:215], a[8:11], a[40:43], v[200:215]
  buffer_load_dwordx4 v13, s[56:59], s39 offen offset:1024 lds
  ds_read_b128 a[28:31], v19 offset:49152
  ds_read_b64_tr_b16 a[60:61], v24 offset:64128
  ds_read_b64_tr_b16 a[62:63], v24 offset:64352
  s_waitcnt lgkmcnt(12)
  v_mfma_f32_32x32x16_bf16 v[200:215], a[12:15], a[44:47], v[200:215]
  s_waitcnt vmcnt(11)
  s_barrier
  ds_read_b128 a[0:3], v20 offset:0
  ds_read_b64_tr_b16 a[32:33], v25 offset:12288
  ds_read_b64_tr_b16 a[34:35], v25 offset:12512
  s_waitcnt lgkmcnt(12)
  v_mfma_f32_32x32x16_bf16 v[200:215], a[16:19], a[48:51], v[200:215]
  ds_read_b128 a[4:7], v21 offset:0
  ds_read_b64_tr_b16 a[36:37], v25 offset:13184
  ds_read_b64_tr_b16 a[38:39], v25 offset:13408
  s_waitcnt lgkmcnt(12)
  v_mfma_f32_32x32x16_bf16 v[200:215], a[20:23], a[52:55], v[200:215]
  ds_read_b128 a[8:11], v22 offset:0
  ds_read_b64_tr_b16 a[40:41], v25 offset:14080
  ds_read_b64_tr_b16 a[42:43], v25 offset:14304
  s_waitcnt lgkmcnt(12)
  v_mfma_f32_32x32x16_bf16 v[200:215], a[24:27], a[56:59], v[200:215]
  ds_read_b128 a[12:15], v23 offset:0
  ds_read_b64_tr_b16 a[44:45], v25 offset:14976
  ds_read_b64_tr_b16 a[46:47], v25 offset:15200
  s_waitcnt lgkmcnt(12)
  v_mfma_f32_32x32x16_bf16 v[200:215], a[28:31], a[60:63], v[200:215]
  s_waitcnt vmcnt(7)
  s_barrier
  ds_read_b128 a[16:19], v20 offset:16384
  ds_read_b64_tr_b16 a[48:49], v25 offset:28672
  ds_read_b64_tr_b16 a[50:51], v25 offset:28896
  s_waitcnt lgkmcnt(12)
  v_mfma_f32_32x32x16_bf16 v[200:215], a[0:3], a[32:35], v[200:215]
  ds_read_b128 a[20:23], v21 offset:16384
  ds_read_b64_tr_b16 a[52:53], v25 offset:29568
  ds_read_b64_tr_b16 a[54:55], v25 offset:29792
  s_waitcnt lgkmcnt(12)
  v_mfma_f32_32x32x16_bf16 v[200:215], a[4:7], a[36:39], v[200:215]
  ds_read_b128 a[24:27], v22 offset:16384
  ds_read_b64_tr_b16 a[56:57], v25 offset:30464
  ds_read_b64_tr_b16 a[58:59], v25 offset:30688
  s_waitcnt lgkmcnt(12)
  v_mfma_f32_32x32x16_bf16 v[200:215], a[8:11], a[40:43], v[200:215]
  ds_read_b128 a[28:31], v23 offset:16384
  ds_read_b64_tr_b16 a[60:61], v25 offset:31360
  ds_read_b64_tr_b16 a[62:63], v25 offset:31584
  s_waitcnt lgkmcnt(12)
  v_mfma_f32_32x32x16_bf16 v[200:215], a[12:15], a[44:47], v[200:215]
  s_waitcnt vmcnt(3)
  s_barrier
  ds_read_b128 a[0:3], v20 offset:32768
  ds_read_b64_tr_b16 a[32:33], v25 offset:45056
  ds_read_b64_tr_b16 a[34:35], v25 offset:45280
  s_waitcnt lgkmcnt(12)
  v_mfma_f32_32x32x16_bf16 v[200:215], a[16:19], a[48:51], v[200:215]
  ds_read_b128 a[4:7], v21 offset:32768
  ds_read_b64_tr_b16 a[36:37], v25 offset:45952
  ds_read_b64_tr_b16 a[38:39], v25 offset:46176
  s_waitcnt lgkmcnt(12)
  v_mfma_f32_32x32x16_bf16 v[200:215], a[20:23], a[52:55], v[200:215]
  ds_read_b128 a[8:11], v22 offset:32768
  ds_read_b64_tr_b16 a[40:41], v25 offset:46848
  ds_read_b64_tr_b16 a[42:43], v25 offset:47072
  s_waitcnt lgkmcnt(12)
  v_mfma_f32_32x32x16_bf16 v[200:215], a[24:27], a[56:59], v[200:215]
  ds_read_b128 a[12:15], v23 offset:32768
  ds_read_b64_tr_b16 a[44:45], v25 offset:47744
  ds_read_b64_tr_b16 a[46:47], v25 offset:47968
  s_waitcnt lgkmcnt(12)
  v_mfma_f32_32x32x16_bf16 v[200:215], a[28:31], a[60:63], v[200:215]
  s_waitcnt lgkmcnt(9)
  v_mfma_f32_32x32x16_bf16 v[200:215], a[0:3], a[32:35], v[200:215]
  s_waitcnt lgkmcnt(6)
  v_mfma_f32_32x32x16_bf16 v[200:215], a[4:7], a[36:39], v[200:215]
  s_waitcnt lgkmcnt(3)
  v_mfma_f32_32x32x16_bf16 v[200:215], a[8:11], a[40:43], v[200:215]
  s_waitcnt lgkmcnt(0)
  v_mfma_f32_32x32x16_bf16 v[200:215], a[12:15], a[44:47], v[200:215]
  s_nop 11
  v_cvt_pk_bf16_f32 v48, v200, v201
  v_cvt_pk_bf16_f32 v49, v202, v203
  v_cvt_pk_bf16_f32 v50, v204, v205
  v_cvt_pk_bf16_f32 v51, v206, v207
  v_cndmask_b32 v48, v48, v31, s[22:23]
  v_cndmask_b32 v49, v49, v31, s[22:23]
  v_cndmask_b32 v50, v50, v31, s[22:23]
  v_cndmask_b32 v51, v51, v31, s[22:23]
  buffer_store_dwordx4 v[48:51], v1, s[52:55], s69 offen offset:2048 sc1
  v_cvt_pk_bf16_f32 v52, v208, v209
  v_cvt_pk_bf16_f32 v53, v210, v211
  v_cvt_pk_bf16_f32 v54, v212, v213
  v_cvt_pk_bf16_f32 v55, v214, v215
  v_cndmask_b32 v52, v52, v31, s[22:23]
  v_cndmask_b32 v53, v53, v31, s[22:23]
  v_cndmask_b32 v54, v54, v31, s[22:23]
  v_cndmask_b32 v55, v55, v31, s[22:23]
  buffer_store_dwordx4 v[52:55], v1, s[52:55], s69 offen offset:3072 sc1
  buffer_load_dword v35, v35, s[16:19], 0 offen sc1
  s_branch k_p1b
k_last:
k_fallback:
  s_waitcnt vmcnt(0)
  s_mov_b32 s36, 1
  v_bfe_u32 v4, v0, 3, 2
  v_mul_u32_u24 v4, 7, v4
  v_lshrrev_b32 v5, 5, v0
  v_add_u32 v4, v4, v5
  v_and_b32 v5, 7, v0
  v_lshlrev_b32 v5, 4, v5
  v_lshrrev_b32 v6, 2, v4
  v_lshl_add_u32 v7, v6, 8, v5
  v_and_b32 v6, 1, v4
  v_lshl_add_u32 v7, v6, 7, v7
  v_bfe_u32 v6, v4, 1, 1
  v_lshl_add_u32 v7, v6, 3, v7
  s_add_u32 s8, s3, 1
  s_and_b32 s4, s8, 3
  s_mul_i32 s8, s4, 1792
  s_add_u32 s8, s8, 65536
  v_add_u32 v40, s8, v7
  s_add_u32 s8, s3, 2
  s_and_b32 s5, s8, 3
  s_mul_i32 s8, s5, 1792
  s_add_u32 s8, s8, 65536
  v_add_u32 v42, s8, v7
  s_add_u32 s8, s3, 3
  s_and_b32 s6, s8, 3
  s_mul_i32 s8, s6, 1792
  s_add_u32 s8, s8, 65536
  v_add_u32 v44, s8, v7
  s_add_u32 s8, s3, 4
  s_and_b32 s7, s8, 3
  s_mul_i32 s8, s7, 1792
  s_add_u32 s8, s8, 65536
  v_add_u32 v46, s8, v7
  v_add_u32 v4, 2, v4
  v_lshrrev_b32 v6, 2, v4
  v_lshl_add_u32 v7, v6, 8, v5
  v_and_b32 v6, 1, v4
  v_lshl_add_u32 v7, v6, 7, v7
  v_bfe_u32 v6, v4, 1, 1
  v_lshl_add_u32 v7, v6, 3, v7
  s_mul_i32 s8, s4, 1792
  s_add_u32 s8, s8, 65536
  v_add_u32 v41, s8, v7
  s_mul_i32 s8, s5, 1792
  s_add_u32 s8, s8, 65536
  v_add_u32 v43, s8, v7
  s_mul_i32 s8, s6, 1792
  s_add_u32 s8, s8, 65536
  v_add_u32 v45, s8, v7
  s_mul_i32 s8, s7, 1792
  s_add_u32 s8, s8, 65536
  v_add_u32 v47, s8, v7
  v_mov_b64 v[126:127], 0
  v_mov_b32 v4, 0xff800000
  v_mov_b64 v[134:135], 0
  v_mov_b32 v5, 0xff800000
  v_mov_b64 v[142:143], 0
  v_mov_b32 v6, 0xff800000
  v_mov_b64 v[150:151], 0
  v_mov_b32 v7, 0xff800000
  ds_read_b64 v[120:121], v40 offset:0
  ds_read_b64 v[122:123], v41 offset:0
  ds_read_b64 v[124:125], v40 offset:256
  s_mov_b32 exec_hi, 0
  ds_read_b64 v[126:127], v41 offset:256
  ds_read_b64 v[134:135], v43 offset:256
  ds_read_b64 v[142:143], v45 offset:256
  ds_read_b64 v[150:151], v47 offset:256
  s_mov_b32 exec_hi, -1
  ds_read_b64 v[128:129], v42 offset:0
  ds_read_b64 v[130:131], v43 offset:0
  ds_read_b64 v[132:133], v42 offset:256
  ds_read_b64 v[136:137], v44 offset:0
  ds_read_b64 v[138:139], v45 offset:0
  ds_read_b64 v[140:141], v44 offset:256
  ds_read_b64 v[144:145], v46 offset:0
  ds_read_b64 v[146:147], v47 offset:0
  ds_read_b64 v[148:149], v46 offset:256
  s_lshl_b32 s39, s3, 16
  s_add_u32 s39, s39, 2097152
  s_add_u32 s10, s28, s39
  s_addc_u32 s11, s29, 0
  s_mov_b32 s67, 0
  s_waitcnt lgkmcnt(0)
fb_loop:
  global_load_dwordx4 v[152:155], v1, s[10:11] offset:0 sc1
  global_load_dwordx4 v[156:159], v1, s[10:11] offset:1024 sc1
  s_add_u32 s10, s10, 4096
  s_addc_u32 s11, s11, 0
  s_waitcnt vmcnt(1)
  v_mfma_f32_32x32x16_bf16 v[8:23], v[152:155], v[120:123], 0
  s_waitcnt vmcnt(0)
  v_mfma_f32_32x32x16_bf16 v[8:23], v[156:159], v[124:127], v[8:23]
  s_nop 11
  v_max3_f32 v4, v4, v8, v9
  v_max3_f32 v4, v4, v10, v11
  v_max3_f32 v4, v4, v12, v13
  v_max3_f32 v4, v4, v14, v15
  v_max3_f32 v4, v4, v16, v17
  v_max3_f32 v4, v4, v18, v19
  v_max3_f32 v4, v4, v20, v21
  v_max3_f32 v4, v4, v22, v23
  v_mfma_f32_32x32x16_bf16 v[8:23], v[152:155], v[128:131], 0
  v_mfma_f32_32x32x16_bf16 v[8:23], v[156:159], v[132:135], v[8:23]
  s_nop 11
  v_max3_f32 v5, v5, v8, v9
  v_max3_f32 v5, v5, v10, v11
  v_max3_f32 v5, v5, v12, v13
  v_max3_f32 v5, v5, v14, v15
  v_max3_f32 v5, v5, v16, v17
  v_max3_f32 v5, v5, v18, v19
  v_max3_f32 v5, v5, v20, v21
  v_max3_f32 v5, v5, v22, v23
  v_mfma_f32_32x32x16_bf16 v[8:23], v[152:155], v[136:139], 0
  v_mfma_f32_32x32x16_bf16 v[8:23], v[156:159], v[140:143], v[8:23]
  s_nop 11
  v_max3_f32 v6, v6, v8, v9
  v_max3_f32 v6, v6, v10, v11
  v_max3_f32 v6, v6, v12, v13
  v_max3_f32 v6, v6, v14, v15
  v_max3_f32 v6, v6, v16, v17
  v_max3_f32 v6, v6, v18, v19
  v_max3_f32 v6, v6, v20, v21
  v_max3_f32 v6, v6, v22, v23
  v_mfma_f32_32x32x16_bf16 v[8:23], v[152:155], v[144:147], 0
  v_mfma_f32_32x32x16_bf16 v[8:23], v[156:159], v[148:151], v[8:23]
  s_nop 11
  v_max3_f32 v7, v7, v8, v9
  v_max3_f32 v7, v7, v10, v11
  v_max3_f32 v7, v7, v12, v13
  v_max3_f32 v7, v7, v14, v15
  v_max3_f32 v7, v7, v16, v17
  v_max3_f32 v7, v7, v18, v19
  v_max3_f32 v7, v7, v20, v21
  v_max3_f32 v7, v7, v22, v23
  s_add_u32 s67, s67, 1
  s_cmp_lt_u32 s67, 16
  s_nop 1
  s_cbranch_scc1 fb_loop
  v_lshlrev_b32 v8, 2, v0
  s_lshl_b32 s67, s3, 8
  v_mov_b32 v9, v4
  s_nop 1
  v_permlane32_swap_b32 v9, v4
  v_max_f32 v9, v9, v4
  s_lshl_b32 s68, s4, 10
  v_add_u32 v12, s68, v8
  v_add_u32 v10, s67, v12
  ds_write_b32 v10, v9 offset:57600
  v_mov_b32 v9, v5
  s_nop 1
  v_permlane32_swap_b32 v9, v5
  v_max_f32 v9, v9, v5
  s_lshl_b32 s68, s5, 10
  v_add_u32 v13, s68, v8
  v_add_u32 v10, s67, v13
  ds_write_b32 v10, v9 offset:57600
  v_mov_b32 v9, v6
  s_nop 1
  v_permlane32_swap_b32 v9, v6
  v_max_f32 v9, v9, v6
  s_lshl_b32 s68, s6, 10
  v_add_u32 v14, s68, v8
  v_add_u32 v10, s67, v14
  ds_write_b32 v10, v9 offset:57600
  v_mov_b32 v9, v7
  s_nop 1
  v_permlane32_swap_b32 v9, v7
  v_max_f32 v9, v9, v7
  s_lshl_b32 s68, s7, 10
  v_add_u32 v15, s68, v8
  v_add_u32 v10, s67, v15
  ds_write_b32 v10, v9 offset:57600
  s_waitcnt lgkmcnt(0)
  s_barrier
  s_mov_b32 s67, 0x07060302
  ds_read_b32 v16, v12 offset:57600
  ds_read_b32 v17, v12 offset:57856
  ds_read_b32 v18, v12 offset:58112
  ds_read_b32 v19, v12 offset:58368
  s_waitcnt lgkmcnt(1)
  v_max3_f32 v16, v16, v17, v18
  s_waitcnt lgkmcnt(0)
  v_max_f32 v16, v16, v19
  v_xor_b32 v16, 0x80000000, v16
  v_and_b32 v17, 0xffff0000, v16
  v_sub_f32 v18, v16, v17
  v_and_b32 v19, 0xffff0000, v18
  v_sub_f32 v18, v18, v19
  v_perm_b32 v126, v19, v17, s67
  v_lshrrev_b32 v127, 16, v18
  ds_read_b32 v16, v13 offset:57600
  ds_read_b32 v17, v13 offset:57856
  ds_read_b32 v18, v13 offset:58112
  ds_read_b32 v19, v13 offset:58368
  s_waitcnt lgkmcnt(1)
  v_max3_f32 v16, v16, v17, v18
  s_waitcnt lgkmcnt(0)
  v_max_f32 v16, v16, v19
  v_xor_b32 v16, 0x80000000, v16
  v_and_b32 v17, 0xffff0000, v16
  v_sub_f32 v18, v16, v17
  v_and_b32 v19, 0xffff0000, v18
  v_sub_f32 v18, v18, v19
  v_perm_b32 v134, v19, v17, s67
  v_lshrrev_b32 v135, 16, v18
  ds_read_b32 v16, v14 offset:57600
  ds_read_b32 v17, v14 offset:57856
  ds_read_b32 v18, v14 offset:58112
  ds_read_b32 v19, v14 offset:58368
  s_waitcnt lgkmcnt(1)
  v_max3_f32 v16, v16, v17, v18
  s_waitcnt lgkmcnt(0)
  v_max_f32 v16, v16, v19
  v_xor_b32 v16, 0x80000000, v16
  v_and_b32 v17, 0xffff0000, v16
  v_sub_f32 v18, v16, v17
  v_and_b32 v19, 0xffff0000, v18
  v_sub_f32 v18, v18, v19
  v_perm_b32 v142, v19, v17, s67
  v_lshrrev_b32 v143, 16, v18
  ds_read_b32 v16, v15 offset:57600
  ds_read_b32 v17, v15 offset:57856
  ds_read_b32 v18, v15 offset:58112
  ds_read_b32 v19, v15 offset:58368
  s_waitcnt lgkmcnt(1)
  v_max3_f32 v16, v16, v17, v18
  s_waitcnt lgkmcnt(0)
  v_max_f32 v16, v16, v19
  v_xor_b32 v16, 0x80000000, v16
  v_and_b32 v17, 0xffff0000, v16
  v_sub_f32 v18, v16, v17
  v_and_b32 v19, 0xffff0000, v18
  v_sub_f32 v18, v18, v19
  v_perm_b32 v150, v19, v17, s67
  v_lshrrev_b32 v151, 16, v18
  v_mov_b32 v255, 1
  v_lshlrev_b32 v254, 24, v0
  v_and_b32 v4, 15, v0
  v_min_u32 v3, 6, v4
  s_lshl_b32 s4, s30, 10
  v_lshl_add_u32 v3, v3, 7, s4
  v_min_u32 v251, 13, v4
  s_lshl_b32 s4, s3, 11
  s_add_u32 s5, s4, 32768
  v_cmp_lt_u32 vcc, 15, v0
  v_lshl_add_u32 v251, v251, 7, s5
  v_and_b32 v4, 7, v0
  v_cmp_lt_u32 vcc, 31, v0
  s_lshl2_add_u32 s4, s4, 896
  v_lshl_add_u32 v4, v4, 10, s4
  s_nop 0
  v_cndmask_b32 v3, v3, v4, vcc
  s_and_b32 s8, s2, 7
  s_lshl1_add_u32 s8, s8, s71
  s_min_u32 s8, s8, 13
  s_lshr_b32 s9, s2, 3
  s_lshl_b32 s4, s72, 9
  s_add_u32 s9, s9, s4
  s_sub_u32 s4, 13, s8
  s_cmp_ge_u32 s8, 7
  s_cselect_b64 vcc, -1, 0
  s_cselect_b32 s4, s4, s8
  s_cselect_b32 s5, 63, 31
  s_lshr_b32 s6, s2, 6
  s_lshl3_add_u32 s4, s6, s4
  s_lshl_b32 s4, s4, 7
  s_add_u32 s4, s4, 40960
  v_and_b32 v252, s5, v0
  v_lshl_add_u32 v252, v252, 2, s4
  v_mov_b32 v2, 0xdddd
  v_and_b32 v4, 15, v0
  v_lshrrev_b32 v5, 4, v0
  v_lshlrev_b32 v6, 7, v5
  v_add_u32 v6, s9, v6
  v_sub_u32 v7, 928, v6
  v_sub_u32 v250, 0x800, v6
  v_and_b32 v250, 0x7ff, v250
  v_sub_u32 v248, 15, v4
  v_cndmask_b32 v248, v4, v248, vcc
  v_lshlrev_b32 v248, 3, v248
  v_lshl_add_u32 v248, v5, 14, v248
  v_cndmask_b32 v249, v6, v7, vcc
  v_cndmask_b32 v250, v6, v250, vcc
  s_lshl_b32 s4, s8, 6
  s_add_u32 s4, s4, 896
  v_lshl_add_u32 v7, v4, 2, s4
  s_mov_b32 s4, 1792
  v_mad_u32_u24 v249, v249, s4, v7
  v_mad_u32_u24 v250, v250, s4, v7
  v_lshl_add_u32 v6, v4, 5, s9
  v_cvt_f32_u32 v6, v6
  v_mul_f32 v6, 973078528, v6
  v_lshlrev_b32 v7, 3, v5
  v_cvt_f32_u32 v7, v7
  v_mul_f32 v152, v6, v7
  s_mov_b32 s4, 0x42000000
  v_fma_f32 v156, v6, s4, v152
  v_add_f32 v160, v6, v152
  v_add_f32 v164, v6, v156
  v_fma_f32 v153, v6, 2.0, v152
  v_fma_f32 v157, v6, 2.0, v156
  v_fma_f32 v161, v6, 2.0, v160
  v_fma_f32 v165, v6, 2.0, v164
  v_fma_f32 v154, v6, 2.0, v153
  v_fma_f32 v158, v6, 2.0, v157
  v_fma_f32 v162, v6, 2.0, v161
  v_fma_f32 v166, v6, 2.0, v165
  v_fma_f32 v155, v6, 2.0, v154
  v_fma_f32 v159, v6, 2.0, v158
  v_fma_f32 v163, v6, 2.0, v162
  v_fma_f32 v167, v6, 2.0, v166
  v_bfe_u32 v4, v0, 3, 2
  v_mul_u32_u24 v4, 7, v4
  v_lshrrev_b32 v5, 5, v0
  v_add_u32 v4, v4, v5
  v_and_b32 v5, 7, v0
  v_lshlrev_b32 v5, 4, v5
  v_lshrrev_b32 v6, 2, v4
  v_lshl_add_u32 v7, v6, 8, v5
  v_and_b32 v6, 1, v4
  v_lshl_add_u32 v7, v6, 7, v7
  v_bfe_u32 v6, v4, 1, 1
  v_lshl_add_u32 v7, v6, 3, v7
  s_add_u32 s8, s3, 1
  s_and_b32 s4, s8, 3
  s_mul_i32 s8, s4, 1792
  s_add_u32 s8, s8, 65536
  v_add_u32 v40, s8, v7
  s_add_u32 s8, s3, 2
  s_and_b32 s5, s8, 3
  s_mul_i32 s8, s5, 1792
  s_add_u32 s8, s8, 65536
  v_add_u32 v42, s8, v7
  s_add_u32 s8, s3, 3
  s_and_b32 s6, s8, 3
  s_mul_i32 s8, s6, 1792
  s_add_u32 s8, s8, 65536
  v_add_u32 v44, s8, v7
  s_add_u32 s8, s3, 4
  s_and_b32 s7, s8, 3
  s_mul_i32 s8, s7, 1792
  s_add_u32 s8, s8, 65536
  v_add_u32 v46, s8, v7
  v_add_u32 v4, 2, v4
  v_lshrrev_b32 v6, 2, v4
  v_lshl_add_u32 v7, v6, 8, v5
  v_and_b32 v6, 1, v4
  v_lshl_add_u32 v7, v6, 7, v7
  v_bfe_u32 v6, v4, 1, 1
  v_lshl_add_u32 v7, v6, 3, v7
  s_mul_i32 s8, s4, 1792
  s_add_u32 s8, s8, 65536
  v_add_u32 v41, s8, v7
  s_mul_i32 s8, s5, 1792
  s_add_u32 s8, s8, 65536
  v_add_u32 v43, s8, v7
  s_mul_i32 s8, s6, 1792
  s_add_u32 s8, s8, 65536
  v_add_u32 v45, s8, v7
  s_mul_i32 s8, s7, 1792
  s_add_u32 s8, s8, 65536
  v_add_u32 v47, s8, v7
  s_lshl_b32 s8, s3, 11
  s_min_u32 s8, s8, 5120
  s_add_u32 s8, s8, 65536
  v_add_u32 v39, s8, v1
  s_mul_i32 s8, s3, 12288
  v_add_u32 v4, s8, v1
  s_mul_i32 s8, s6, 12288
  v_add_u32 v5, s8, v1
  s_mul_i32 s8, s5, 12288
  v_add_u32 v6, s8, v1
  s_mul_i32 s8, s4, 12288
  v_add_u32 v7, s8, v1
  v_cos_f32 v168, v152
  v_sin_f32 v152, v152
  v_cos_f32 v169, v153
  v_sin_f32 v153, v153
  v_cos_f32 v170, v154
  v_sin_f32 v154, v154
  v_cos_f32 v171, v155
  v_sin_f32 v155, v155
  v_cos_f32 v172, v156
  v_sin_f32 v156, v156
  v_cos_f32 v173, v157
  v_sin_f32 v157, v157
  v_cos_f32 v174, v158
  v_sin_f32 v158, v158
  v_cos_f32 v175, v159
  v_sin_f32 v159, v159
  v_cos_f32 v176, v160
  v_sin_f32 v160, v160
  v_cos_f32 v177, v161
  v_sin_f32 v161, v161
  v_cos_f32 v178, v162
  v_sin_f32 v162, v162
  v_cos_f32 v179, v163
  v_sin_f32 v163, v163
  v_cos_f32 v180, v164
  v_sin_f32 v164, v164
  v_cos_f32 v181, v165
  v_sin_f32 v165, v165
  v_cos_f32 v182, v166
  v_sin_f32 v166, v166
  v_cos_f32 v183, v167
  v_sin_f32 v167, v167
  v_cvt_pk_bf16_f32 v216, v168, v152
  v_cvt_pk_bf16_f32 v217, v169, v153
  v_cvt_pk_bf16_f32 v218, v170, v154
  v_cvt_pk_bf16_f32 v219, v171, v155
  v_cvt_pk_bf16_f32 v220, v172, v156
  v_cvt_pk_bf16_f32 v221, v173, v157
  v_cvt_pk_bf16_f32 v222, v174, v158
  v_cvt_pk_bf16_f32 v223, v175, v159
  v_cvt_pk_bf16_f32 v224, v176, v160
  v_cvt_pk_bf16_f32 v225, v177, v161
  v_cvt_pk_bf16_f32 v226, v178, v162
  v_cvt_pk_bf16_f32 v227, v179, v163
  v_cvt_pk_bf16_f32 v228, v180, v164
  v_cvt_pk_bf16_f32 v229, v181, v165
  v_cvt_pk_bf16_f32 v230, v182, v166
  v_cvt_pk_bf16_f32 v231, v183, v167
  v_mov_b64 v[56:57], 0
  v_mov_b64 v[58:59], 0
  v_mov_b64 v[60:61], 0
  v_mov_b64 v[62:63], 0
  v_mov_b64 v[64:65], 0
  v_mov_b64 v[66:67], 0
  v_mov_b64 v[68:69], 0
  v_mov_b64 v[70:71], 0
  v_mov_b64 v[72:73], 0
  v_mov_b64 v[74:75], 0
  v_mov_b64 v[76:77], 0
  v_mov_b64 v[78:79], 0
  v_mov_b64 v[80:81], 0
  v_mov_b64 v[82:83], 0
  v_mov_b64 v[84:85], 0
  v_mov_b64 v[86:87], 0
  v_mov_b64 v[88:89], 0
  v_mov_b64 v[90:91], 0
  v_mov_b64 v[92:93], 0
  v_mov_b64 v[94:95], 0
  v_mov_b64 v[96:97], 0
  v_mov_b64 v[98:99], 0
  v_mov_b64 v[100:101], 0
  v_mov_b64 v[102:103], 0
  v_mov_b64 v[104:105], 0
  v_mov_b64 v[106:107], 0
  v_mov_b64 v[108:109], 0
  v_mov_b64 v[110:111], 0
  v_mov_b64 v[112:113], 0
  v_mov_b64 v[114:115], 0
  v_mov_b64 v[116:117], 0
  v_mov_b64 v[118:119], 0
  s_add_u32 s20, s28, 5242880
  s_addc_u32 s21, s29, 0
  s_lshl3_add_u32 s26, s30, s31
  s_lshl_b32 s65, s3, 11
  s_min_u32 s65, s65, 5120
  s_mul_i32 s39, s26, 7168
  s_add_u32 s39, s39, s65
  s_add_u32 s22, s28, s39
  s_addc_u32 s23, s29, 0
  s_lshl_b32 s39, s3, 16
  s_add_u32 s39, s39, 2101248
  s_add_u32 s4, s28, s39
  s_addc_u32 s5, s29, 0
  s_mul_i32 s39, s3, 100352
  s_add_u32 s39, s39, 2363392
  s_add_u32 s6, s28, s39
  s_addc_u32 s7, s29, 0
  s_and_b32 s65, s2, 7
  s_cmp_lt_u32 s65, 7
  s_cselect_b32 s46, 3670016, 0
  s_mov_b64 s[44:45], s[24:25]
  s_mov_b32 s47, 0x20000
  s_mov_b64 s[40:41], s[24:25]
  s_mov_b32 s42, 3670016
  s_mov_b32 s43, 0x20000
  s_lshl1_add_u32 s65, s65, s71
  s_min_u32 s65, s65, 13
  s_lshl3_add_u32 s27, s3, s31
  s_lshl_b32 s27, s27, 7
  s_lshl2_add_u32 s27, s30, s27
  s_add_u32 s27, s27, 5283840
  s_lshl_b32 s39, s65, 4
  s_sub_u32 s68, 209, s39
  s_cmp_ge_u32 s65, 7
  s_cselect_b32 s68, s68, s39
  s_cselect_b32 s67, -8, 0
  s_lshr_b32 s39, s2, 3
  s_lshl_b32 s39, s39, 16
  s_lshl3_add_u32 s68, s68, s39
  s_add_u32 s68, s68, 3149824
  s_add_u32 s67, s67, s68
  s_add_u32 s67, s67, 1024
  s_add_u32 s8, s28, s68
  s_addc_u32 s9, s29, 0
  s_add_u32 s10, s28, s67
  s_addc_u32 s11, s29, 0
  s_add_u32 s12, s8, 8192
  s_addc_u32 s13, s9, 0
  s_add_u32 s14, s10, 8192
  s_addc_u32 s15, s11, 0
  s_cmp_ge_u32 s65, 7
  s_cselect_b32 s64, -1, 1
  s_cselect_b32 s66, 2007040, 0
  s_mul_i32 s39, s64, 57344
  s_add_u32 s57, s39, s66
  s_mul_i32 s39, s64, 114688
  s_add_u32 s58, s39, s66
  s_mul_i32 s39, s64, 172032
  s_add_u32 s59, s39, s66
  s_mul_i32 s39, s64, 1835008
  s_add_u32 s60, s39, s66
  s_mul_i32 s39, s64, 1892352
  s_add_u32 s61, s39, s66
  s_mul_i32 s39, s64, 1949696
  s_add_u32 s62, s39, s66
  s_mul_i32 s39, s64, 2007040
  s_add_u32 s63, s39, s66
  v_mov_b32 v3, 0x7f000000
  v_mov_b32 v38, 0
  s_mov_b32 s69, 0
  s_mov_b32 s70, 0
  global_load_dwordx4 v[48:51], v1, s[22:23] offset:0 sc1
  global_load_dwordx4 v[52:55], v1, s[22:23] offset:1024 sc1
  global_load_dwordx4 v[152:155], v1, s[4:5] offset:-4096 sc1
  global_load_dwordx4 v[156:159], v1, s[4:5] offset:-3072 sc1
  global_load_dwordx4 v[160:163], v1, s[4:5] offset:-2048 sc1
  global_load_dwordx4 v[164:167], v1, s[4:5] offset:-1024 sc1
  global_load_dwordx4 v[168:171], v1, s[4:5] offset:0 sc1
  global_load_dwordx4 v[172:175], v1, s[4:5] offset:1024 sc1
  s_branch k_restart
  s_endpgm
.section .rodata,"a"
.p2align 6
.amdhsa_kernel concat_heads__grouped_kv_mqa__spectral_fnet__prompt_kernel
  .amdhsa_next_free_vgpr 512
  .amdhsa_next_free_sgpr 102
  .amdhsa_accum_offset 256
  .amdhsa_group_segment_fixed_size 0
  .amdhsa_kernarg_size 104
  .amdhsa_user_sgpr_count 2
  .amdhsa_user_sgpr_kernarg_segment_ptr 1
  .amdhsa_system_sgpr_workgroup_id_x 1
.end_amdhsa_kernel
```
